```python
import torch

def _softmax(x, axis=-1):
    return torch.softmax(x, dim=axis)
def _gelu(x):
    return torch.nn.functional.gelu(x, approximate="tanh")
def _silu(x):
    return torch.nn.functional.silu(x)
def _sigmoid(x):
    return torch.sigmoid(x)
def _layernorm(x, axis=-1, eps=1e-5):
    m = x.mean(dim=axis, keepdim=True)
    v = x.var(dim=axis, keepdim=True, unbiased=False)
    return (x - m) / torch.sqrt(v + eps)
def _scatter_add(tgt, idx, src, axis=0):
    return tgt.clone().index_add_(axis, idx, src)
def _segment_sum(src, seg, n):
    out = torch.zeros((n,) + src.shape[1:], dtype=src.dtype)
    return out.index_add_(0, seg, src)
def _pad(x, pw):
    flat = tuple(v for pair in reversed(pw) for v in pair)
    return torch.nn.functional.pad(x, flat)

kernel_name = 'parallel_sum__sliding_block_cached__glu_gated_swiglu__decode'

def setup_inputs():

    _w = (lambda a: (lambda t: t.to(torch.bfloat16) if t.is_floating_point() else t)(torch.as_tensor(a)))
    def _A_setup():
        B, Sq, D = 4, 1, 640
        Hq, Hkv, Sk, Dh = 32, 32, 8192, 192
        assert Hq % Hkv == 0, (Hq, Hkv)
        return {
            "x": _w((lambda *s: torch.randn(*s, dtype=torch.bfloat16) * 0.05)(B, Sq, D)),
            "k_cache": _w((lambda *s: torch.randn(*s, dtype=torch.bfloat16) * 1.6)(B, Hkv, Sk, Dh)),
            "v_cache": _w((lambda *s: torch.randn(*s, dtype=torch.bfloat16) * 0.8)(B, Hkv, Sk, Dh)),
            "wq": _w((lambda *s: torch.randn(*s, dtype=torch.bfloat16) * 1.6)(D, Hq * Dh) * (D ** -0.5)),
            "wo": _w((lambda *s: torch.randn(*s, dtype=torch.bfloat16) * 0.8)(Hq * Dh, D) * ((Hq * Dh) ** -0.5)),
        }
    _A_in = _A_setup()

    def _B_setup():
        B, S, D, F = 4, 1, 640, 1536
        return {
            "x": _w((lambda *s: torch.randn(*s, dtype=torch.bfloat16) * 0.05)(B, S, D)),
            "w1": _w((lambda *s: torch.randn(*s, dtype=torch.bfloat16) * 0.4)(D, F) * (2.0 / D) ** 0.5),
            "w3": _w((lambda *s: torch.randn(*s, dtype=torch.bfloat16) * 0.4)(D, F) * (2.0 / D) ** 0.5),
            "w2": _w((lambda *s: torch.randn(*s, dtype=torch.bfloat16) * 0.4)(F, D) * (2.0 / F) ** 0.5),
        }
    _B_in = _B_setup()

    return {
        "A_x": _A_in["x"],
        "A_k_cache": _A_in["k_cache"],
        "A_v_cache": _A_in["v_cache"],
        "A_wq": _A_in["wq"],
        "A_wo": _A_in["wo"],
        "B_x": _B_in["x"],
        "B_w1": _B_in["w1"],
        "B_w3": _B_in["w3"],
        "B_w2": _B_in["w2"],
    }

def reference(A_x, A_k_cache, A_v_cache, A_wq, A_wo, B_x, B_w1, B_w3, B_w2):
    def _A_ref(x, k_cache, v_cache, wq, wo):
        B, Sq, D = x.shape
        Hq, Dh = 32, 192
        Hkv, Sk = k_cache.shape[1], k_cache.shape[2]
        W = min(4096, max(256, Sk // 4))
        rep = Hq // Hkv
        q = (lambda x, *d: x.permute(*d))((x @ wq).reshape(B, Sq, Hq, Dh), 0, 2, 1, 3)
        k = (lambda x, n, axis: torch.repeat_interleave(x, n, dim=axis))(k_cache[:, :, Sk - W:, :], rep, axis=1)
        v = (lambda x, n, axis: torch.repeat_interleave(x, n, dim=axis))(v_cache[:, :, Sk - W:, :], rep, axis=1)
        scores = torch.einsum("bhqd,bhkd->bhqk", q, k) * (Dh ** -0.5)
        p = _softmax(scores, axis=-1)
        o = torch.einsum("bhqk,bhkd->bhqd", p, v)
        return (lambda x, *d: x.permute(*d))(o, 0, 2, 1, 3).reshape(B, Sq, Hq * Dh) @ wo

    def _B_ref(x, w1, w3, w2):
        gate = torch.einsum("bsd,df->bsf", x, w1)
        up = torch.einsum("bsd,df->bsf", x, w3)
        h = _silu(gate) * up
        out = torch.einsum("bsf,fd->bsd", h, w2)
        return out

    x = A_x
    xn = _layernorm(x, axis=-1)
    return x + _A_ref(xn, A_k_cache, A_v_cache, A_wq, A_wo) + _B_ref(xn, B_w1, B_w3, B_w2)
```

```asm
; @launch grid=(256,1,1) block=(512,1,1) lds=112128
.amdgcn_target "amdgcn-amd-amdhsa--gfx950"
.text
.globl parallel_sum__sliding_block_cached__glu_gated_swiglu__decode_kernel
.p2align 8
.type parallel_sum__sliding_block_cached__glu_gated_swiglu__decode_kernel,@function
parallel_sum__sliding_block_cached__glu_gated_swiglu__decode_kernel:
  s_load_dwordx16 s[4:19], s[0:1], 0
  s_load_dwordx8 s[20:27], s[0:1], 64
  v_lshrrev_b32 v2, 6, v0
  s_cmpk_ge_u32 s2, 0x100
  s_cbranch_scc1 L_end
  v_readfirstlane_b32 s60, v2
  s_nop 0
  s_cmp_lt_u32 s60, 4
  s_cbranch_scc1 L_pad
  v_and_b32 v0, 63, v0
  s_and_b32 s61, s2, 7
  s_lshr_b32 s62, s2, 3
  s_lshr_b32 s65, s2, 6
  s_lshl2_add_u32 s65, s61, s65
  s_bfe_u32 s66, s2, 0x20004
  s_and_b32 s67, s62, 1
  v_mul_u32_u24 v2, 26, v0
  v_lshrrev_b32 v2, 8, v2
  v_mul_u32_u24 v3, 10, v2
  v_sub_u32 v3, v0, v3
  v_mul_u32_u24 v2, 1280, v2
  v_lshl_add_u32 v2, v3, 4, v2
  s_lshl2_add_u32 s64, s67, s66
  s_lshl2_add_u32 s78, s65, s60
  s_sub_u32 s78, s78, 4
  s_mul_i32 s71, s64, 160
  s_mul_i32 s77, s78, 61440
  s_add_u32 s77, s77, s71
  s_mov_b32 s42, 60320
  s_mov_b32 s43, 0x20000
  s_mul_i32 s70, s60, 7680
  s_sub_u32 m0, s70, 13696
  s_movk_i32 s70, 960
  s_mov_b32 exec_hi, 0x0fffffff
  s_setprio 2
  s_waitcnt lgkmcnt(0)
  s_add_u32 s40, s12, s77
  s_addc_u32 s41, s13, 0
  buffer_load_dwordx4 v2, s[40:43], 0 offen nt lds
  s_add_u32 m0, m0, s70
  s_movk_i32 s69, 7680
  buffer_load_dwordx4 v2, s[40:43], s69 offen nt lds
  s_add_u32 m0, m0, s70
  s_addk_i32 s69, 7680
  buffer_load_dwordx4 v2, s[40:43], s69 offen nt lds
  s_add_u32 m0, m0, s70
  s_addk_i32 s69, 7680
  buffer_load_dwordx4 v2, s[40:43], s69 offen nt lds
  s_branch L_padskip
L_pad:
  s_branch L_old
L_padskip:
  s_add_u32 m0, m0, s70
  s_addk_i32 s69, 7680
  buffer_load_dwordx4 v2, s[40:43], s69 offen nt lds
  s_add_u32 m0, m0, s70
  s_addk_i32 s69, 7680
  buffer_load_dwordx4 v2, s[40:43], s69 offen nt lds
  s_add_u32 m0, m0, s70
  s_addk_i32 s69, 7680
  buffer_load_dwordx4 v2, s[40:43], s69 offen nt lds
  s_add_u32 m0, m0, s70
  s_addk_i32 s69, 7680
  buffer_load_dwordx4 v2, s[40:43], s69 offen nt lds
  s_mul_i32 s77, s78, 15360
  s_add_u32 s77, s77, s71
  s_add_u32 s44, s20, s77
  s_addc_u32 s45, s21, 0
  s_mov_b32 s46, 14240
  s_mov_b32 s47, 0x20000
  s_mul_i32 s69, s60, 1920
  s_add_u32 m0, s69, 40064
  s_movk_i32 s69, 7680
  buffer_load_dwordx4 v2, s[44:47], 0 offen nt lds
  s_add_u32 m0, m0, s70
  s_nop 0
  buffer_load_dwordx4 v2, s[44:47], s69 offen nt lds
  s_mov_b32 exec_hi, -1
  s_lshl_b32 s69, s66, 5
  s_add_u32 s69, s69, s65
  s_lshl_b32 s69, s69, 10
  s_addk_i32 s69, 768
  s_mul_i32 s72, s69, 3072
  s_mul_i32 s3, s60, 11
  s_add_u32 s3, s3, 212
  s_mul_i32 s71, s67, 44
  s_add_u32 s3, s3, s71
  s_and_b32 s3, s3, 255
  v_lshrrev_b32 v5, 3, v0
  v_and_b32 v6, 7, v0
  v_mul_u32_u24 v1, 384, v5
  v_lshl_add_u32 v1, v6, 4, v1
  s_mov_b32 s30, 786432
  s_mov_b32 s31, 0x20000
  s_add_u32 s28, s6, s72
  s_addc_u32 s29, s7, 0
  s_barrier
L_krest:
  s_mov_b32 s75, s3
  s_mul_i32 s69, s75, 3072
  buffer_load_dwordx4 v[64:67], v1, s[28:31], s69 offen offset:0 nt
  buffer_load_dwordx4 v[68:71], v1, s[28:31], s69 offen offset:128 nt
  buffer_load_dwordx4 v[72:75], v1, s[28:31], s69 offen offset:256 nt
  s_add_u32 s75, s75, 88
  s_and_b32 s75, s75, 255
  s_mul_i32 s69, s75, 3072
  buffer_load_dwordx4 v[76:79], v1, s[28:31], s69 offen offset:0 nt
  buffer_load_dwordx4 v[80:83], v1, s[28:31], s69 offen offset:128 nt
  buffer_load_dwordx4 v[84:87], v1, s[28:31], s69 offen offset:256 nt
  s_waitcnt vmcnt(3)
  s_add_u32 s75, s75, 88
  s_and_b32 s75, s75, 255
  s_mul_i32 s69, s75, 3072
  buffer_load_dwordx4 v[88:91], v1, s[28:31], s69 offen offset:0 nt
  buffer_load_dwordx4 v[92:95], v1, s[28:31], s69 offen offset:128 nt
  buffer_load_dwordx4 v[96:99], v1, s[28:31], s69 offen offset:256 nt
  s_waitcnt vmcnt(3)
  s_add_u32 s75, s75, 88
  s_and_b32 s75, s75, 255
  s_mul_i32 s69, s75, 3072
  buffer_load_dwordx4 v[100:103], v1, s[28:31], s69 offen offset:0 nt
  buffer_load_dwordx4 v[104:107], v1, s[28:31], s69 offen offset:128 nt
  buffer_load_dwordx4 v[108:111], v1, s[28:31], s69 offen offset:256 nt
  s_waitcnt vmcnt(3)
  s_add_u32 s75, s75, 88
  s_and_b32 s75, s75, 255
  s_mul_i32 s69, s75, 3072
  buffer_load_dwordx4 v[112:115], v1, s[28:31], s69 offen offset:0 nt
  buffer_load_dwordx4 v[116:119], v1, s[28:31], s69 offen offset:128 nt
  buffer_load_dwordx4 v[120:123], v1, s[28:31], s69 offen offset:256 nt
  s_waitcnt vmcnt(3)
  s_add_u32 s75, s75, 88
  s_and_b32 s75, s75, 255
  s_mul_i32 s69, s75, 3072
  buffer_load_dwordx4 v[124:127], v1, s[28:31], s69 offen offset:0 nt
  buffer_load_dwordx4 v[128:131], v1, s[28:31], s69 offen offset:128 nt
  buffer_load_dwordx4 v[132:135], v1, s[28:31], s69 offen offset:256 nt
  s_waitcnt vmcnt(3)
  s_add_u32 s75, s75, 88
  s_and_b32 s75, s75, 255
  s_mul_i32 s69, s75, 3072
  buffer_load_dwordx4 v[136:139], v1, s[28:31], s69 offen offset:0 nt
  buffer_load_dwordx4 v[140:143], v1, s[28:31], s69 offen offset:128 nt
  buffer_load_dwordx4 v[144:147], v1, s[28:31], s69 offen offset:256 nt
  s_waitcnt vmcnt(3)
  s_add_u32 s75, s75, 88
  s_and_b32 s75, s75, 255
  s_mul_i32 s69, s75, 3072
  buffer_load_dwordx4 v[148:151], v1, s[28:31], s69 offen offset:0 nt
  buffer_load_dwordx4 v[152:155], v1, s[28:31], s69 offen offset:128 nt
  buffer_load_dwordx4 v[156:159], v1, s[28:31], s69 offen offset:256 nt
  s_waitcnt vmcnt(3)
  s_add_u32 s75, s75, 88
  s_and_b32 s75, s75, 255
  s_mul_i32 s69, s75, 3072
  buffer_load_dwordx4 v[160:163], v1, s[28:31], s69 offen offset:0 nt
  buffer_load_dwordx4 v[164:167], v1, s[28:31], s69 offen offset:128 nt
  buffer_load_dwordx4 v[168:171], v1, s[28:31], s69 offen offset:256 nt
  s_waitcnt vmcnt(3)
  s_add_u32 s75, s75, 88
  s_and_b32 s75, s75, 255
  s_mul_i32 s69, s75, 3072
  buffer_load_dwordx4 v[172:175], v1, s[28:31], s69 offen offset:0 nt
  buffer_load_dwordx4 v[176:179], v1, s[28:31], s69 offen offset:128 nt
  buffer_load_dwordx4 v[180:183], v1, s[28:31], s69 offen offset:256 nt
  s_waitcnt vmcnt(3)
  s_add_u32 s75, s75, 88
  s_and_b32 s75, s75, 255
  s_mul_i32 s69, s75, 3072
  buffer_load_dwordx4 v[184:187], v1, s[28:31], s69 offen offset:0 nt
  buffer_load_dwordx4 v[188:191], v1, s[28:31], s69 offen offset:128 nt
  buffer_load_dwordx4 v[192:195], v1, s[28:31], s69 offen offset:256 nt
  s_waitcnt vmcnt(3)
  s_add_u32 s75, s75, 88
  s_and_b32 s75, s75, 255
  s_mul_i32 s69, s75, 3072
  buffer_load_dwordx4 v[196:199], v1, s[28:31], s69 offen offset:0 nt
  buffer_load_dwordx4 v[200:203], v1, s[28:31], s69 offen offset:128 nt
  buffer_load_dwordx4 v[204:207], v1, s[28:31], s69 offen offset:256 nt
  s_waitcnt vmcnt(3)
  s_add_u32 s75, s75, 88
  s_and_b32 s75, s75, 255
  s_mul_i32 s69, s75, 3072
  buffer_load_dwordx4 v[208:211], v1, s[28:31], s69 offen offset:0 nt
  buffer_load_dwordx4 v[212:215], v1, s[28:31], s69 offen offset:128 nt
  buffer_load_dwordx4 v[216:219], v1, s[28:31], s69 offen offset:256 nt
  s_waitcnt vmcnt(3)
  s_add_u32 s75, s75, 88
  s_and_b32 s75, s75, 255
  s_mul_i32 s69, s75, 3072
  buffer_load_dwordx4 v[220:223], v1, s[28:31], s69 offen offset:0 nt
  buffer_load_dwordx4 v[224:227], v1, s[28:31], s69 offen offset:128 nt
  buffer_load_dwordx4 v[228:231], v1, s[28:31], s69 offen offset:256 nt
  s_waitcnt vmcnt(3)
  s_add_u32 s75, s75, 88
  s_and_b32 s75, s75, 255
  s_mul_i32 s69, s75, 3072
  buffer_load_dwordx4 v[232:235], v1, s[28:31], s69 offen offset:0 nt
  buffer_load_dwordx4 v[236:239], v1, s[28:31], s69 offen offset:128 nt
  buffer_load_dwordx4 v[240:243], v1, s[28:31], s69 offen offset:256 nt
  s_waitcnt vmcnt(3)
  s_add_u32 s75, s75, 88
  s_and_b32 s75, s75, 255
  s_mul_i32 s69, s75, 3072
  buffer_load_dwordx4 v[244:247], v1, s[28:31], s69 offen offset:0 nt
  buffer_load_dwordx4 v[248:251], v1, s[28:31], s69 offen offset:128 nt
  buffer_load_dwordx4 v[252:255], v1, s[28:31], s69 offen offset:256 nt
  s_branch L_kdone
L_old:
  s_setprio 3
  v_and_b32 v0, 63, v0
  s_and_b32 s61, s2, 7
  s_lshr_b32 s62, s2, 3
  s_lshr_b32 s65, s2, 6
  s_lshl2_add_u32 s65, s61, s65
  s_bfe_u32 s66, s2, 0x20004
  s_and_b32 s67, s62, 1
  s_lshl_b32 s69, s66, 5
  s_add_u32 s69, s69, s65
  s_lshl_b32 s69, s69, 10
  s_addk_i32 s69, 768
  s_mul_i32 s72, s69, 3072
  s_mul_i32 s3, s60, 11
  s_add_u32 s3, s3, 128
  s_mul_i32 s71, s67, 44
  s_add_u32 s3, s3, s71
  s_and_b32 s3, s3, 255
  v_lshrrev_b32 v5, 3, v0
  v_and_b32 v6, 7, v0
  v_mul_u32_u24 v1, 384, v5
  v_lshl_add_u32 v1, v6, 4, v1
  s_mov_b32 s30, 786432
  s_mov_b32 s31, 0x20000
  s_memrealtime s[56:57]
  v_mov_b32 v172, 0
  v_mov_b32 v173, 0
  v_mov_b32 v174, 0
  v_mov_b32 v175, 0
  s_mul_i32 s69, s60, 576
  v_and_b32 v2, 1, v0
  v_lshlrev_b32 v2, 4, v2
  ds_write_b128 v2, v[172:175] offset:416
  v_add_u32 v2, s69, v2
  ds_write_b128 v2, v[172:175] offset:61088
  s_waitcnt lgkmcnt(0)
  s_add_u32 s28, s6, s72
  s_addc_u32 s29, s7, 0
  s_or_b32 s69, s2, s60
  s_cbranch_scc1 L_nonw
  s_mul_i32 s69, s56, 0x9e3779b1
  s_max_u32 s69, s69, 1
  v_mov_b32 v3, s69
  s_mov_b64 exec, 1
  global_store_dword v172, v3, s[24:25] sc1
  s_mov_b64 exec, -1
L_nonw:
  s_cmp_ge_u32 s62, 30
  s_cbranch_scc1 L_p1skip
  s_mul_i32 s69, s60, 1280
  s_add_u32 s48, s4, s69
  s_addc_u32 s49, s5, 0
  s_movk_i32 s50, 1280
  s_mov_b32 s51, 0x20000
  v_lshlrev_b32 v7, 5, v0
  s_mul_i32 s76, s62, 205
  s_lshr_b32 s76, s76, 10
  s_mul_i32 s69, s76, 5
  s_sub_u32 s77, s62, s69
  s_cmp_eq_u32 s76, 5
  s_cselect_b64 s[52:53], s[18:19], s[16:17]
  s_lshl2_add_u32 s69, s61, s76
  s_cmp_lt_u32 s76, 4
  s_cselect_b64 s[52:53], s[10:11], s[52:53]
  s_cselect_b32 s69, s69, s61
  s_cselect_b32 s78, 4, 1
  s_mulk_i32 s78, 3072
  s_mulk_i32 s69, 384
  s_lshl2_add_u32 s71, s77, s60
  s_mul_i32 s71, s71, s78
  s_lshl_b32 s71, s71, 5
  s_add_u32 s69, s69, s71
  s_add_u32 s52, s52, s69
  s_addc_u32 s53, s53, 0
  s_mul_i32 s54, s78, 31
  s_addk_i32 s54, 384
  s_mov_b32 s55, 0x20000
  v_lshlrev_b32 v4, 4, v6
  v_mad_u32_u24 v4, v5, s78, v4
  s_lshl_b32 s78, s78, 3
  s_lshl_b32 s71, s60, 12
  s_add_u32 m0, s71, 62976
  s_mov_b32 s69, 0
  buffer_load_dwordx4 v4, s[52:55], s69 offen offset:0 nt lds
  s_add_u32 m0, m0, 16256
  s_nop 0
  buffer_load_dwordx4 v4, s[52:55], s69 offen offset:128 nt lds
  s_add_u32 m0, m0, 16256
  s_nop 0
  buffer_load_dwordx4 v4, s[52:55], s69 offen offset:256 nt lds
  s_sub_u32 m0, m0, 31488
  s_add_u32 s69, s69, s78
  buffer_load_dwordx4 v4, s[52:55], s69 offen offset:0 nt lds
  s_add_u32 m0, m0, 16256
  s_nop 0
  buffer_load_dwordx4 v4, s[52:55], s69 offen offset:128 nt lds
  s_add_u32 m0, m0, 16256
  s_nop 0
  buffer_load_dwordx4 v4, s[52:55], s69 offen offset:256 nt lds
  s_sub_u32 m0, m0, 31488
  s_add_u32 s69, s69, s78
  buffer_load_dwordx4 v[64:67], v7, s[48:51], 0 offen
  buffer_load_dwordx4 v[68:71], v7, s[48:51], 0 offen offset:16
  buffer_load_dwordx4 v4, s[52:55], s69 offen offset:0 nt lds
  s_add_u32 m0, m0, 16256
  s_nop 0
  buffer_load_dwordx4 v4, s[52:55], s69 offen offset:128 nt lds
  s_add_u32 m0, m0, 16256
  s_nop 0
  buffer_load_dwordx4 v4, s[52:55], s69 offen offset:256 nt lds
  s_sub_u32 m0, m0, 31488
  s_add_u32 s69, s69, s78
  buffer_load_dwordx4 v4, s[52:55], s69 offen offset:0 nt lds
  s_add_u32 m0, m0, 16256
  s_nop 0
  buffer_load_dwordx4 v4, s[52:55], s69 offen offset:128 nt lds
  s_add_u32 m0, m0, 16256
  s_nop 0
  buffer_load_dwordx4 v4, s[52:55], s69 offen offset:256 nt lds
  s_barrier
  s_mul_i32 s79, s61, 92160
  s_mul_i32 s69, s77, 4608
  s_add_u32 s79, s79, s69
  s_lshl2_add_u32 s69, s76, s60
  s_mulk_i32 s69, 192
  s_add_u32 s79, s79, s69
  v_lshrrev_b32 v4, 4, v0
  v_and_b32 v2, 3, v0
  v_mul_u32_u24 v3, 1296, v2
  v_lshl_add_u32 v3, v4, 4, v3
  s_lshl_b32 s69, s77, 8
  v_add_u32 v3, s69, v3
  v_bfe_u32 v12, v0, 2, 2
  v_mul_u32_u24 v11, 23040, v2
  v_lshl_add_u32 v11, v12, 6, v11
  v_lshl_add_u32 v11, v4, 4, v11
  v_lshl_add_u32 v12, v4, 3, v12
  v_lshlrev_b32 v12, 7, v12
  v_lshl_add_u32 v12, v2, 3, v12
  s_mul_i32 s69, s60, 1296
  v_add_u32 v7, s69, v7
  s_mul_i32 s77, s60, 3
  s_lshr_b32 s69, s77, 2
  s_lshl_b32 s69, s69, 14
  s_and_b32 s71, s77, 3
  s_lshl_b32 s71, s71, 5
  s_add_u32 s69, s69, s71
  s_add_u32 s69, s69, 62976
  v_add_u32 v8, s69, v12
  s_add_u32 s77, s77, 1
  s_lshr_b32 s69, s77, 2
  s_lshl_b32 s69, s69, 14
  s_and_b32 s71, s77, 3
  s_lshl_b32 s71, s71, 5
  s_add_u32 s69, s69, s71
  s_add_u32 s69, s69, 62976
  v_add_u32 v9, s69, v12
  s_add_u32 s77, s77, 1
  s_lshr_b32 s69, s77, 2
  s_lshl_b32 s69, s69, 14
  s_and_b32 s71, s77, 3
  s_lshl_b32 s71, s71, 5
  s_add_u32 s69, s69, s71
  s_add_u32 s69, s69, 62976
  v_add_u32 v10, s69, v12
  s_add_u32 s32, s8, s72
  s_addc_u32 s33, s9, 0
  s_mov_b32 s0, 0
  s_mov_b32 s1, 16
  s_and_b32 s63, s65, 3
  s_lshl2_add_u32 s64, s67, s66
  s_mov_b32 s68, 0xffff0000
  s_mov_b32 s34, 786432
  s_mov_b32 s35, 0x20000
  s_mov_b32 s38, 4194304
  s_mov_b32 s39, 0x20000
  s_mov_b32 s50, 5120
  s_mov_b32 s51, 0x20000
  s_mov_b32 s54, 5120
  s_mov_b32 s55, 0x20000
  s_mov_b64 s[36:37], s[26:27]
  s_mov_b64 s[48:49], s[4:5]
  s_mov_b64 s[52:53], s[22:23]
  s_xor_b32 s15, s60, 4
  v_mov_b32 v166, 0
  s_waitcnt vmcnt(6)
  v_lshlrev_b32 v72, 16, v64
  v_and_b32 v73, s68, v64
  v_lshlrev_b32 v74, 16, v65
  v_and_b32 v75, s68, v65
  v_lshlrev_b32 v76, 16, v66
  v_and_b32 v77, s68, v66
  v_lshlrev_b32 v78, 16, v67
  v_and_b32 v79, s68, v67
  v_lshlrev_b32 v80, 16, v68
  v_and_b32 v81, s68, v68
  v_lshlrev_b32 v82, 16, v69
  v_and_b32 v83, s68, v69
  v_lshlrev_b32 v84, 16, v70
  v_and_b32 v85, s68, v70
  v_lshlrev_b32 v86, 16, v71
  v_and_b32 v87, s68, v71
  v_pk_add_f32 v[164:165], v[72:73], v[74:75]
  v_pk_add_f32 v[168:169], v[76:77], v[78:79]
  v_pk_add_f32 v[164:165], v[164:165], v[80:81]
  v_pk_add_f32 v[168:169], v[168:169], v[82:83]
  v_pk_add_f32 v[164:165], v[164:165], v[84:85]
  v_pk_add_f32 v[168:169], v[168:169], v[86:87]
  v_pk_add_f32 v[164:165], v[164:165], v[168:169]
  v_add_f32 v164, v164, v165
  s_nop 1
  v_add_f32_dpp v164, v164, v164 row_ror:8 row_mask:0xf bank_mask:0xf
  s_nop 1
  v_add_f32_dpp v164, v164, v164 row_ror:4 row_mask:0xf bank_mask:0xf
  s_nop 1
  v_add_f32_dpp v164, v164, v164 row_ror:2 row_mask:0xf bank_mask:0xf
  s_nop 1
  v_add_f32_dpp v164, v164, v164 row_ror:1 row_mask:0xf bank_mask:0xf
  v_mov_b32 v165, v164
  s_nop 1
  v_permlane16_swap_b32 v164, v165
  v_add_f32 v164, v164, v165
  v_mov_b32 v165, v164
  s_nop 1
  v_permlane32_swap_b32 v164, v165
  v_add_f32 v164, v164, v165
  v_mul_f32 v164, 0x3acccccd, v164
  s_mov_b32 exec_hi, 0xff
  v_pk_add_f32 v[104:105], v[72:73], v[164:165] op_sel_hi:[1,0] neg_lo:[0,1] neg_hi:[0,1]
  v_pk_add_f32 v[106:107], v[74:75], v[164:165] op_sel_hi:[1,0] neg_lo:[0,1] neg_hi:[0,1]
  v_pk_add_f32 v[108:109], v[76:77], v[164:165] op_sel_hi:[1,0] neg_lo:[0,1] neg_hi:[0,1]
  v_pk_add_f32 v[110:111], v[78:79], v[164:165] op_sel_hi:[1,0] neg_lo:[0,1] neg_hi:[0,1]
  v_pk_add_f32 v[112:113], v[80:81], v[164:165] op_sel_hi:[1,0] neg_lo:[0,1] neg_hi:[0,1]
  v_pk_add_f32 v[114:115], v[82:83], v[164:165] op_sel_hi:[1,0] neg_lo:[0,1] neg_hi:[0,1]
  v_pk_add_f32 v[116:117], v[84:85], v[164:165] op_sel_hi:[1,0] neg_lo:[0,1] neg_hi:[0,1]
  v_pk_add_f32 v[118:119], v[86:87], v[164:165] op_sel_hi:[1,0] neg_lo:[0,1] neg_hi:[0,1]
  v_pk_mul_f32 v[168:169], v[104:105], v[104:105]
  v_pk_mul_f32 v[170:171], v[106:107], v[106:107]
  v_pk_fma_f32 v[168:169], v[108:109], v[108:109], v[168:169]
  v_pk_fma_f32 v[170:171], v[110:111], v[110:111], v[170:171]
  v_pk_fma_f32 v[168:169], v[112:113], v[112:113], v[168:169]
  v_pk_fma_f32 v[170:171], v[114:115], v[114:115], v[170:171]
  v_pk_fma_f32 v[168:169], v[116:117], v[116:117], v[168:169]
  v_pk_fma_f32 v[170:171], v[118:119], v[118:119], v[170:171]
  v_pk_add_f32 v[168:169], v[168:169], v[170:171]
  v_add_f32 v166, v168, v169
  s_mov_b32 exec_hi, -1
  s_nop 1
  v_add_f32_dpp v166, v166, v166 row_ror:8 row_mask:0xf bank_mask:0xf
  s_nop 1
  v_add_f32_dpp v166, v166, v166 row_ror:4 row_mask:0xf bank_mask:0xf
  s_nop 1
  v_add_f32_dpp v166, v166, v166 row_ror:2 row_mask:0xf bank_mask:0xf
  s_nop 1
  v_add_f32_dpp v166, v166, v166 row_ror:1 row_mask:0xf bank_mask:0xf
  v_mov_b32 v167, v166
  s_nop 1
  v_permlane16_swap_b32 v166, v167
  v_add_f32 v166, v166, v167
  v_mov_b32 v167, v166
  s_nop 1
  v_permlane32_swap_b32 v166, v167
  v_add_f32 v166, v166, v167
  v_mul_f32 v166, 0x3acccccd, v166
  v_cvt_pk_bf16_f32 v165, v164, v164
  v_lshlrev_b32 v164, 16, v165
  v_cvt_pk_bf16_f32 v167, v166, v166
  v_lshlrev_b32 v166, 16, v167
  v_add_f32 v166, 0x3727c5ac, v166
  v_cvt_pk_bf16_f32 v167, v166, v166
  v_lshlrev_b32 v166, 16, v167
  v_sqrt_f32 v166, v166
  s_nop 0
  v_cvt_pk_bf16_f32 v167, v166, v166
  v_lshlrev_b32 v166, 16, v167
  v_rcp_f32 v166, v166
  v_pk_add_f32 v[72:73], v[72:73], v[164:165] op_sel_hi:[1,0] neg_lo:[0,1] neg_hi:[0,1]
  v_pk_add_f32 v[74:75], v[74:75], v[164:165] op_sel_hi:[1,0] neg_lo:[0,1] neg_hi:[0,1]
  v_pk_add_f32 v[76:77], v[76:77], v[164:165] op_sel_hi:[1,0] neg_lo:[0,1] neg_hi:[0,1]
  v_pk_add_f32 v[78:79], v[78:79], v[164:165] op_sel_hi:[1,0] neg_lo:[0,1] neg_hi:[0,1]
  v_pk_add_f32 v[80:81], v[80:81], v[164:165] op_sel_hi:[1,0] neg_lo:[0,1] neg_hi:[0,1]
  v_pk_add_f32 v[82:83], v[82:83], v[164:165] op_sel_hi:[1,0] neg_lo:[0,1] neg_hi:[0,1]
  v_pk_add_f32 v[84:85], v[84:85], v[164:165] op_sel_hi:[1,0] neg_lo:[0,1] neg_hi:[0,1]
  v_pk_add_f32 v[86:87], v[86:87], v[164:165] op_sel_hi:[1,0] neg_lo:[0,1] neg_hi:[0,1]
  v_cvt_pk_bf16_f32 v64, v72, v73
  v_cvt_pk_bf16_f32 v65, v74, v75
  v_cvt_pk_bf16_f32 v66, v76, v77
  v_cvt_pk_bf16_f32 v67, v78, v79
  v_cvt_pk_bf16_f32 v68, v80, v81
  v_cvt_pk_bf16_f32 v69, v82, v83
  v_cvt_pk_bf16_f32 v70, v84, v85
  v_cvt_pk_bf16_f32 v71, v86, v87
  v_lshlrev_b32 v72, 16, v64
  v_and_b32 v73, s68, v64
  v_lshlrev_b32 v74, 16, v65
  v_and_b32 v75, s68, v65
  v_lshlrev_b32 v76, 16, v66
  v_and_b32 v77, s68, v66
  v_lshlrev_b32 v78, 16, v67
  v_and_b32 v79, s68, v67
  v_lshlrev_b32 v80, 16, v68
  v_and_b32 v81, s68, v68
  v_lshlrev_b32 v82, 16, v69
  v_and_b32 v83, s68, v69
  v_lshlrev_b32 v84, 16, v70
  v_and_b32 v85, s68, v70
  v_lshlrev_b32 v86, 16, v71
  v_and_b32 v87, s68, v71
  v_pk_mul_f32 v[72:73], v[72:73], v[166:167] op_sel_hi:[1,0]
  v_pk_mul_f32 v[74:75], v[74:75], v[166:167] op_sel_hi:[1,0]
  v_pk_mul_f32 v[76:77], v[76:77], v[166:167] op_sel_hi:[1,0]
  v_pk_mul_f32 v[78:79], v[78:79], v[166:167] op_sel_hi:[1,0]
  v_pk_mul_f32 v[80:81], v[80:81], v[166:167] op_sel_hi:[1,0]
  v_pk_mul_f32 v[82:83], v[82:83], v[166:167] op_sel_hi:[1,0]
  v_pk_mul_f32 v[84:85], v[84:85], v[166:167] op_sel_hi:[1,0]
  v_pk_mul_f32 v[86:87], v[86:87], v[166:167] op_sel_hi:[1,0]
  v_cvt_pk_bf16_f32 v64, v72, v73
  v_cvt_pk_bf16_f32 v65, v74, v75
  v_cvt_pk_bf16_f32 v66, v76, v77
  v_cvt_pk_bf16_f32 v67, v78, v79
  v_cvt_pk_bf16_f32 v68, v80, v81
  v_cvt_pk_bf16_f32 v69, v82, v83
  v_cvt_pk_bf16_f32 v70, v84, v85
  v_cvt_pk_bf16_f32 v71, v86, v87
  s_mov_b32 exec_hi, 0xff
  ds_write_b128 v7, v[64:67] offset:55424
  ds_write_b128 v7, v[68:71] offset:55440
  s_waitcnt vmcnt(3)
  s_mov_b64 exec, 1
  global_load_dword v4, v172, s[24:25] sc1
  v_mov_b32 v2, 1
  s_waitcnt vmcnt(1) lgkmcnt(0)
  s_mov_b64 exec, 1
  ds_add_u32 v172, v2 offset:424
  s_mov_b64 exec, -1
  v_mov_b32 v7, 0xffffff00
L_spin0:
  ds_read_b32 v2, v172 offset:424
  s_waitcnt lgkmcnt(0)
  v_readfirstlane_b32 s69, v2
  s_nop 0
  s_cmp_eq_u32 s69, 4
  s_cbranch_scc1 L_spin0_ok
  s_sleep 1
  s_add_u32 s0, s0, 1
  s_cmp_lt_u32 s0, 200000
  s_cbranch_scc1 L_spin0
  s_branch L_fin
L_spin0_ok:
  ds_read_b128 v[88:91], v3 offset:55424
  ds_read_b64_tr_b16 v[104:105], v8 offset:0
  ds_read_b64_tr_b16 v[106:107], v8 offset:512
  ds_read_b64_tr_b16 v[108:109], v9 offset:0
  ds_read_b64_tr_b16 v[110:111], v9 offset:512
  ds_read_b64_tr_b16 v[112:113], v10 offset:0
  ds_read_b64_tr_b16 v[114:115], v10 offset:512
  ds_read_b128 v[92:95], v3 offset:55488
  ds_read_b64_tr_b16 v[116:117], v8 offset:4096
  ds_read_b64_tr_b16 v[118:119], v8 offset:4608
  ds_read_b64_tr_b16 v[120:121], v9 offset:4096
  ds_read_b64_tr_b16 v[122:123], v9 offset:4608
  ds_read_b64_tr_b16 v[124:125], v10 offset:4096
  ds_read_b64_tr_b16 v[126:127], v10 offset:4608
  ds_read_b128 v[96:99], v3 offset:55552
  ds_read_b64_tr_b16 v[128:129], v8 offset:8192
  ds_read_b64_tr_b16 v[130:131], v8 offset:8704
  ds_read_b64_tr_b16 v[132:133], v9 offset:8192
  ds_read_b64_tr_b16 v[134:135], v9 offset:8704
  ds_read_b64_tr_b16 v[136:137], v10 offset:8192
  ds_read_b64_tr_b16 v[138:139], v10 offset:8704
  ds_read_b128 v[100:103], v3 offset:55616
  ds_read_b64_tr_b16 v[140:141], v8 offset:12288
  ds_read_b64_tr_b16 v[142:143], v8 offset:12800
  ds_read_b64_tr_b16 v[144:145], v9 offset:12288
  ds_read_b64_tr_b16 v[146:147], v9 offset:12800
  ds_read_b64_tr_b16 v[148:149], v10 offset:12288
  ds_read_b64_tr_b16 v[150:151], v10 offset:12800
  s_waitcnt lgkmcnt(14)
  v_mfma_f32_16x16x32_bf16 v[152:155], v[104:107], v[88:91], 0
  v_mfma_f32_16x16x32_bf16 v[156:159], v[108:111], v[88:91], 0
  v_mfma_f32_16x16x32_bf16 v[160:163], v[112:115], v[88:91], 0
  s_waitcnt lgkmcnt(14)
  v_mfma_f32_16x16x32_bf16 v[152:155], v[116:119], v[92:95], v[152:155]
  v_mfma_f32_16x16x32_bf16 v[156:159], v[120:123], v[92:95], v[156:159]
  v_mfma_f32_16x16x32_bf16 v[160:163], v[124:127], v[92:95], v[160:163]
  s_waitcnt lgkmcnt(7)
  v_mfma_f32_16x16x32_bf16 v[152:155], v[128:131], v[96:99], v[152:155]
  v_mfma_f32_16x16x32_bf16 v[156:159], v[132:135], v[96:99], v[156:159]
  v_mfma_f32_16x16x32_bf16 v[160:163], v[136:139], v[96:99], v[160:163]
  s_waitcnt lgkmcnt(0)
  v_mfma_f32_16x16x32_bf16 v[152:155], v[140:143], v[100:103], v[152:155]
  v_mfma_f32_16x16x32_bf16 v[156:159], v[144:147], v[100:103], v[156:159]
  v_mfma_f32_16x16x32_bf16 v[160:163], v[148:151], v[100:103], v[160:163]
  s_mov_b32 exec_lo, 0xf000f0
  s_mov_b32 exec_hi, 0xf000f0
  s_nop 4
  v_mov_b32 v152, v156
  v_mov_b32 v153, v157
  v_mov_b32 v154, v158
  v_mov_b32 v155, v159
  s_mov_b32 exec_lo, 0xf000f00
  s_mov_b32 exec_hi, 0xf000f00
  v_mov_b32 v152, v160
  v_mov_b32 v153, v161
  v_mov_b32 v154, v162
  v_mov_b32 v155, v163
  s_mov_b64 exec, -1
  s_waitcnt vmcnt(0)
  v_readfirstlane_b32 s14, v4
  s_nop 0
  s_cmp_lg_u32 s14, 0
  s_cbranch_scc1 L_non1_ok
L_non1:
  v_mov_b32 v2, 0
  global_load_dword v2, v2, s[24:25] sc1
  s_waitcnt vmcnt(0)
  v_readfirstlane_b32 s14, v2
  s_nop 0
  s_cmp_lg_u32 s14, 0
  s_cbranch_scc1 L_non1_ok
  s_sleep 16
  s_add_u32 s0, s0, 1
  s_cmp_lt_u32 s0, 200000
  s_cbranch_scc1 L_non1
  s_branch L_fin
L_non1_ok:
  s_add_u32 s73, s14, 0
  s_and_b32 s56, s73, 0xff
  s_bfe_u32 s57, s73, 0x80008
  s_bfe_u32 s58, s73, 0x80010
  s_lshr_b32 s59, s73, 24
  s_mov_b32 exec_lo, 0xfff0fff
  s_mov_b32 exec_hi, 0xfff0fff
  v_add_u32 v60, 0x80, v152
  v_add_u32 v61, 0x80, v153
  v_add_u32 v62, 0x80, v154
  v_add_u32 v63, 0x80, v155
  v_and_or_b32 v60, v60, v7, s56
  v_and_or_b32 v61, v61, v7, s57
  v_and_or_b32 v62, v62, v7, s58
  v_and_or_b32 v63, v63, v7, s59
  buffer_store_dwordx4 v[60:63], v11, s[36:39], s79 offen sc1 nt
  s_mov_b64 exec, -1
  s_branch L_p1done
L_p1skip:
  s_barrier
L_p1done:
  s_barrier
  s_setprio 1
  s_branch L_krest
L_kdone:
  s_load_dword s14, s[24:25], 0
  s_barrier
  s_add_u32 s32, s8, s72
  s_addc_u32 s33, s9, 0
  s_mov_b32 s0, 0
  s_mov_b32 s1, 16
  s_and_b32 s63, s65, 3
  s_lshl2_add_u32 s64, s67, s66
  s_mov_b32 s68, 0xffff0000
  s_mov_b32 s34, 786432
  s_mov_b32 s35, 0x20000
  s_mov_b32 s38, 4194304
  s_mov_b32 s39, 0x20000
  s_mov_b32 s50, 5120
  s_mov_b32 s51, 0x20000
  s_mov_b32 s54, 5120
  s_mov_b32 s55, 0x20000
  s_mov_b64 s[36:37], s[26:27]
  s_mov_b64 s[48:49], s[4:5]
  s_mov_b64 s[52:53], s[22:23]
  s_xor_b32 s15, s60, 4
  s_waitcnt lgkmcnt(0)
  s_cmp_lg_u32 s14, 0
  s_cbranch_scc1 L_non2_ok
L_non2:
  v_mov_b32 v2, 0
  global_load_dword v2, v2, s[24:25] sc1
  s_waitcnt vmcnt(0)
  v_readfirstlane_b32 s14, v2
  s_nop 0
  s_cmp_lg_u32 s14, 0
  s_cbranch_scc1 L_non2_ok
  s_sleep 16
  s_add_u32 s0, s0, 1
  s_cmp_lt_u32 s0, 200000
  s_cbranch_scc1 L_non2
  s_branch L_fin
L_non2_ok:
  s_add_u32 s73, s14, 0
  s_and_b32 s56, s73, 0xff
  s_bfe_u32 s57, s73, 0x80008
  s_bfe_u32 s58, s73, 0x80010
  s_lshr_b32 s59, s73, 24
L_dma:
L_dma_done:
  s_cmp_eq_u32 s60, 7
  s_cbranch_scc1 L_gather
L_waitq:
  v_and_b32 v6, 7, v0
  v_lshlrev_b32 v7, 4, v6
  v_mov_b32 v20, 0
  v_mov_b32 v21, 0
  v_mov_b32 v22, 0
  v_mov_b32 v23, 0
  v_mov_b32 v24, 0
  v_mov_b32 v25, 0
  v_mov_b32 v26, 0
  v_mov_b32 v27, 0
  v_mov_b32 v28, 0
  v_mov_b32 v29, 0
  v_mov_b32 v30, 0
  v_mov_b32 v31, 0
  v_mov_b32 v32, 0
  v_mov_b32 v33, 0
  v_mov_b32 v34, 0
  v_mov_b32 v35, 0
  v_and_b32 v3, 1, v0
  v_lshlrev_b32 v3, 4, v3
  v_mov_b32 v4, 0xffff
  v_lshlrev_b32 v3, v3, v4
  v_lshrrev_b32 v4, 1, v6
  v_cmp_eq_u32 vcc, 0, v4
  s_nop 1
  v_cndmask_b32 v36, 0, v3, vcc
  v_cmp_eq_u32 vcc, 1, v4
  s_nop 1
  v_cndmask_b32 v37, 0, v3, vcc
  v_cmp_eq_u32 vcc, 2, v4
  s_nop 1
  v_cndmask_b32 v38, 0, v3, vcc
  v_cmp_eq_u32 vcc, 3, v4
  s_nop 1
  v_cndmask_b32 v39, 0, v3, vcc
  v_mov_b32 v5, 0
L_spinq:
  ds_read_b32 v2, v5 offset:416
  s_waitcnt lgkmcnt(0)
  v_readfirstlane_b32 s69, v2
  s_nop 0
  s_cmp_eq_u32 s69, 1
  s_cbranch_scc1 L_spinq_ok
  s_sleep 4
  s_add_u32 s0, s0, 1
  s_cmp_lt_u32 s0, 200000
  s_cbranch_scc1 L_spinq
  s_branch L_fin
L_spinq_ok:
  ds_read_b128 v[8:11], v7 offset:0
  ds_read_b128 v[12:15], v7 offset:128
  ds_read_b128 v[16:19], v7 offset:256
  s_waitcnt lgkmcnt(0)
  s_waitcnt vmcnt(42)
  v_dot2c_f32_bf16 v20, v64, v8
  v_dot2c_f32_bf16 v21, v76, v8
  v_dot2c_f32_bf16 v20, v65, v9
  v_dot2c_f32_bf16 v21, v77, v9
  v_dot2c_f32_bf16 v20, v66, v10
  v_dot2c_f32_bf16 v21, v78, v10
  v_dot2c_f32_bf16 v20, v67, v11
  v_dot2c_f32_bf16 v21, v79, v11
  v_dot2c_f32_bf16 v20, v68, v12
  v_dot2c_f32_bf16 v21, v80, v12
  v_dot2c_f32_bf16 v20, v69, v13
  v_dot2c_f32_bf16 v21, v81, v13
  v_dot2c_f32_bf16 v20, v70, v14
  v_dot2c_f32_bf16 v21, v82, v14
  v_dot2c_f32_bf16 v20, v71, v15
  v_dot2c_f32_bf16 v21, v83, v15
  v_dot2c_f32_bf16 v20, v72, v16
  v_dot2c_f32_bf16 v21, v84, v16
  v_dot2c_f32_bf16 v20, v73, v17
  v_dot2c_f32_bf16 v21, v85, v17
  v_dot2c_f32_bf16 v20, v74, v18
  v_dot2c_f32_bf16 v21, v86, v18
  v_dot2c_f32_bf16 v20, v75, v19
  v_dot2c_f32_bf16 v21, v87, v19
  s_waitcnt vmcnt(36)
  v_dot2c_f32_bf16 v22, v88, v8
  v_dot2c_f32_bf16 v23, v100, v8
  v_dot2c_f32_bf16 v22, v89, v9
  v_dot2c_f32_bf16 v23, v101, v9
  v_dot2c_f32_bf16 v22, v90, v10
  v_dot2c_f32_bf16 v23, v102, v10
  v_dot2c_f32_bf16 v22, v91, v11
  v_dot2c_f32_bf16 v23, v103, v11
  v_dot2c_f32_bf16 v22, v92, v12
  v_dot2c_f32_bf16 v23, v104, v12
  v_dot2c_f32_bf16 v22, v93, v13
  v_dot2c_f32_bf16 v23, v105, v13
  v_dot2c_f32_bf16 v22, v94, v14
  v_dot2c_f32_bf16 v23, v106, v14
  v_dot2c_f32_bf16 v22, v95, v15
  v_dot2c_f32_bf16 v23, v107, v15
  v_dot2c_f32_bf16 v22, v96, v16
  v_dot2c_f32_bf16 v23, v108, v16
  v_dot2c_f32_bf16 v22, v97, v17
  v_dot2c_f32_bf16 v23, v109, v17
  v_dot2c_f32_bf16 v22, v98, v18
  v_dot2c_f32_bf16 v23, v110, v18
  v_dot2c_f32_bf16 v22, v99, v19
  v_dot2c_f32_bf16 v23, v111, v19
  s_waitcnt vmcnt(30)
  v_dot2c_f32_bf16 v24, v112, v8
  v_dot2c_f32_bf16 v25, v124, v8
  v_dot2c_f32_bf16 v24, v113, v9
  v_dot2c_f32_bf16 v25, v125, v9
  v_dot2c_f32_bf16 v24, v114, v10
  v_dot2c_f32_bf16 v25, v126, v10
  v_dot2c_f32_bf16 v24, v115, v11
  v_dot2c_f32_bf16 v25, v127, v11
  v_dot2c_f32_bf16 v24, v116, v12
  v_dot2c_f32_bf16 v25, v128, v12
  v_dot2c_f32_bf16 v24, v117, v13
  v_dot2c_f32_bf16 v25, v129, v13
  v_dot2c_f32_bf16 v24, v118, v14
  v_dot2c_f32_bf16 v25, v130, v14
  v_dot2c_f32_bf16 v24, v119, v15
  v_dot2c_f32_bf16 v25, v131, v15
  v_dot2c_f32_bf16 v24, v120, v16
  v_dot2c_f32_bf16 v25, v132, v16
  v_dot2c_f32_bf16 v24, v121, v17
  v_dot2c_f32_bf16 v25, v133, v17
  v_dot2c_f32_bf16 v24, v122, v18
  v_dot2c_f32_bf16 v25, v134, v18
  v_dot2c_f32_bf16 v24, v123, v19
  v_dot2c_f32_bf16 v25, v135, v19
  s_waitcnt vmcnt(24)
  v_dot2c_f32_bf16 v26, v136, v8
  v_dot2c_f32_bf16 v27, v148, v8
  v_dot2c_f32_bf16 v26, v137, v9
  v_dot2c_f32_bf16 v27, v149, v9
  v_dot2c_f32_bf16 v26, v138, v10
  v_dot2c_f32_bf16 v27, v150, v10
  v_dot2c_f32_bf16 v26, v139, v11
  v_dot2c_f32_bf16 v27, v151, v11
  v_dot2c_f32_bf16 v26, v140, v12
  v_dot2c_f32_bf16 v27, v152, v12
  v_dot2c_f32_bf16 v26, v141, v13
  v_dot2c_f32_bf16 v27, v153, v13
  v_dot2c_f32_bf16 v26, v142, v14
  v_dot2c_f32_bf16 v27, v154, v14
  v_dot2c_f32_bf16 v26, v143, v15
  v_dot2c_f32_bf16 v27, v155, v15
  v_dot2c_f32_bf16 v26, v144, v16
  v_dot2c_f32_bf16 v27, v156, v16
  v_dot2c_f32_bf16 v26, v145, v17
  v_dot2c_f32_bf16 v27, v157, v17
  v_dot2c_f32_bf16 v26, v146, v18
  v_dot2c_f32_bf16 v27, v158, v18
  v_dot2c_f32_bf16 v26, v147, v19
  v_dot2c_f32_bf16 v27, v159, v19
  s_waitcnt vmcnt(18)
  v_dot2c_f32_bf16 v28, v160, v8
  v_dot2c_f32_bf16 v29, v172, v8
  v_dot2c_f32_bf16 v28, v161, v9
  v_dot2c_f32_bf16 v29, v173, v9
  v_dot2c_f32_bf16 v28, v162, v10
  v_dot2c_f32_bf16 v29, v174, v10
  v_dot2c_f32_bf16 v28, v163, v11
  v_dot2c_f32_bf16 v29, v175, v11
  v_dot2c_f32_bf16 v28, v164, v12
  v_dot2c_f32_bf16 v29, v176, v12
  v_dot2c_f32_bf16 v28, v165, v13
  v_dot2c_f32_bf16 v29, v177, v13
  v_dot2c_f32_bf16 v28, v166, v14
  v_dot2c_f32_bf16 v29, v178, v14
  v_dot2c_f32_bf16 v28, v167, v15
  v_dot2c_f32_bf16 v29, v179, v15
  v_dot2c_f32_bf16 v28, v168, v16
  v_dot2c_f32_bf16 v29, v180, v16
  v_dot2c_f32_bf16 v28, v169, v17
  v_dot2c_f32_bf16 v29, v181, v17
  v_dot2c_f32_bf16 v28, v170, v18
  v_dot2c_f32_bf16 v29, v182, v18
  v_dot2c_f32_bf16 v28, v171, v19
  v_dot2c_f32_bf16 v29, v183, v19
  s_waitcnt vmcnt(12)
  v_dot2c_f32_bf16 v30, v184, v8
  v_dot2c_f32_bf16 v31, v196, v8
  v_dot2c_f32_bf16 v30, v185, v9
  v_dot2c_f32_bf16 v31, v197, v9
  v_dot2c_f32_bf16 v30, v186, v10
  v_dot2c_f32_bf16 v31, v198, v10
  v_dot2c_f32_bf16 v30, v187, v11
  v_dot2c_f32_bf16 v31, v199, v11
  v_dot2c_f32_bf16 v30, v188, v12
  v_dot2c_f32_bf16 v31, v200, v12
  v_dot2c_f32_bf16 v30, v189, v13
  v_dot2c_f32_bf16 v31, v201, v13
  v_dot2c_f32_bf16 v30, v190, v14
  v_dot2c_f32_bf16 v31, v202, v14
  v_dot2c_f32_bf16 v30, v191, v15
  v_dot2c_f32_bf16 v31, v203, v15
  v_dot2c_f32_bf16 v30, v192, v16
  v_dot2c_f32_bf16 v31, v204, v16
  v_dot2c_f32_bf16 v30, v193, v17
  v_dot2c_f32_bf16 v31, v205, v17
  v_dot2c_f32_bf16 v30, v194, v18
  v_dot2c_f32_bf16 v31, v206, v18
  v_dot2c_f32_bf16 v30, v195, v19
  v_dot2c_f32_bf16 v31, v207, v19
  s_waitcnt vmcnt(6)
  v_dot2c_f32_bf16 v32, v208, v8
  v_dot2c_f32_bf16 v33, v220, v8
  v_dot2c_f32_bf16 v32, v209, v9
  v_dot2c_f32_bf16 v33, v221, v9
  v_dot2c_f32_bf16 v32, v210, v10
  v_dot2c_f32_bf16 v33, v222, v10
  v_dot2c_f32_bf16 v32, v211, v11
  v_dot2c_f32_bf16 v33, v223, v11
  v_dot2c_f32_bf16 v32, v212, v12
  v_dot2c_f32_bf16 v33, v224, v12
  v_dot2c_f32_bf16 v32, v213, v13
  v_dot2c_f32_bf16 v33, v225, v13
  v_dot2c_f32_bf16 v32, v214, v14
  v_dot2c_f32_bf16 v33, v226, v14
  v_dot2c_f32_bf16 v32, v215, v15
  v_dot2c_f32_bf16 v33, v227, v15
  v_dot2c_f32_bf16 v32, v216, v16
  v_dot2c_f32_bf16 v33, v228, v16
  v_dot2c_f32_bf16 v32, v217, v17
  v_dot2c_f32_bf16 v33, v229, v17
  v_dot2c_f32_bf16 v32, v218, v18
  v_dot2c_f32_bf16 v33, v230, v18
  v_dot2c_f32_bf16 v32, v219, v19
  v_dot2c_f32_bf16 v33, v231, v19
  s_waitcnt vmcnt(0)
  v_dot2c_f32_bf16 v34, v232, v8
  v_dot2c_f32_bf16 v35, v244, v8
  v_dot2c_f32_bf16 v34, v233, v9
  v_dot2c_f32_bf16 v35, v245, v9
  v_dot2c_f32_bf16 v34, v234, v10
  v_dot2c_f32_bf16 v35, v246, v10
  v_dot2c_f32_bf16 v34, v235, v11
  v_dot2c_f32_bf16 v35, v247, v11
  v_dot2c_f32_bf16 v34, v236, v12
  v_dot2c_f32_bf16 v35, v248, v12
  v_dot2c_f32_bf16 v34, v237, v13
  v_dot2c_f32_bf16 v35, v249, v13
  v_dot2c_f32_bf16 v34, v238, v14
  v_dot2c_f32_bf16 v35, v250, v14
  v_dot2c_f32_bf16 v34, v239, v15
  v_dot2c_f32_bf16 v35, v251, v15
  v_dot2c_f32_bf16 v34, v240, v16
  v_dot2c_f32_bf16 v35, v252, v16
  v_dot2c_f32_bf16 v34, v241, v17
  v_dot2c_f32_bf16 v35, v253, v17
  v_dot2c_f32_bf16 v34, v242, v18
  v_dot2c_f32_bf16 v35, v254, v18
  v_dot2c_f32_bf16 v34, v243, v19
  v_dot2c_f32_bf16 v35, v255, v19
  v_add_f32_dpp v20, v20, v20 quad_perm:[1,0,3,2] row_mask:0xf bank_mask:0xf
  v_add_f32_dpp v21, v21, v21 quad_perm:[1,0,3,2] row_mask:0xf bank_mask:0xf
  v_add_f32_dpp v22, v22, v22 quad_perm:[1,0,3,2] row_mask:0xf bank_mask:0xf
  v_add_f32_dpp v23, v23, v23 quad_perm:[1,0,3,2] row_mask:0xf bank_mask:0xf
  v_add_f32_dpp v24, v24, v24 quad_perm:[1,0,3,2] row_mask:0xf bank_mask:0xf
  v_add_f32_dpp v25, v25, v25 quad_perm:[1,0,3,2] row_mask:0xf bank_mask:0xf
  v_add_f32_dpp v26, v26, v26 quad_perm:[1,0,3,2] row_mask:0xf bank_mask:0xf
  v_add_f32_dpp v27, v27, v27 quad_perm:[1,0,3,2] row_mask:0xf bank_mask:0xf
  v_add_f32_dpp v28, v28, v28 quad_perm:[1,0,3,2] row_mask:0xf bank_mask:0xf
  v_add_f32_dpp v29, v29, v29 quad_perm:[1,0,3,2] row_mask:0xf bank_mask:0xf
  v_add_f32_dpp v30, v30, v30 quad_perm:[1,0,3,2] row_mask:0xf bank_mask:0xf
  v_add_f32_dpp v31, v31, v31 quad_perm:[1,0,3,2] row_mask:0xf bank_mask:0xf
  v_add_f32_dpp v32, v32, v32 quad_perm:[1,0,3,2] row_mask:0xf bank_mask:0xf
  v_add_f32_dpp v33, v33, v33 quad_perm:[1,0,3,2] row_mask:0xf bank_mask:0xf
  v_add_f32_dpp v34, v34, v34 quad_perm:[1,0,3,2] row_mask:0xf bank_mask:0xf
  v_add_f32_dpp v35, v35, v35 quad_perm:[1,0,3,2] row_mask:0xf bank_mask:0xf
  v_add_f32_dpp v20, v20, v20 quad_perm:[2,3,0,1] row_mask:0xf bank_mask:0xf
  v_add_f32_dpp v21, v21, v21 quad_perm:[2,3,0,1] row_mask:0xf bank_mask:0xf
  v_add_f32_dpp v22, v22, v22 quad_perm:[2,3,0,1] row_mask:0xf bank_mask:0xf
  v_add_f32_dpp v23, v23, v23 quad_perm:[2,3,0,1] row_mask:0xf bank_mask:0xf
  v_add_f32_dpp v24, v24, v24 quad_perm:[2,3,0,1] row_mask:0xf bank_mask:0xf
  v_add_f32_dpp v25, v25, v25 quad_perm:[2,3,0,1] row_mask:0xf bank_mask:0xf
  v_add_f32_dpp v26, v26, v26 quad_perm:[2,3,0,1] row_mask:0xf bank_mask:0xf
  v_add_f32_dpp v27, v27, v27 quad_perm:[2,3,0,1] row_mask:0xf bank_mask:0xf
  v_add_f32_dpp v28, v28, v28 quad_perm:[2,3,0,1] row_mask:0xf bank_mask:0xf
  v_add_f32_dpp v29, v29, v29 quad_perm:[2,3,0,1] row_mask:0xf bank_mask:0xf
  v_add_f32_dpp v30, v30, v30 quad_perm:[2,3,0,1] row_mask:0xf bank_mask:0xf
  v_add_f32_dpp v31, v31, v31 quad_perm:[2,3,0,1] row_mask:0xf bank_mask:0xf
  v_add_f32_dpp v32, v32, v32 quad_perm:[2,3,0,1] row_mask:0xf bank_mask:0xf
  v_add_f32_dpp v33, v33, v33 quad_perm:[2,3,0,1] row_mask:0xf bank_mask:0xf
  v_add_f32_dpp v34, v34, v34 quad_perm:[2,3,0,1] row_mask:0xf bank_mask:0xf
  v_add_f32_dpp v35, v35, v35 quad_perm:[2,3,0,1] row_mask:0xf bank_mask:0xf
  v_add_f32_dpp v20, v20, v20 row_half_mirror row_mask:0xf bank_mask:0xf
  v_add_f32_dpp v21, v21, v21 row_half_mirror row_mask:0xf bank_mask:0xf
  v_add_f32_dpp v22, v22, v22 row_half_mirror row_mask:0xf bank_mask:0xf
  v_add_f32_dpp v23, v23, v23 row_half_mirror row_mask:0xf bank_mask:0xf
  v_add_f32_dpp v24, v24, v24 row_half_mirror row_mask:0xf bank_mask:0xf
  v_add_f32_dpp v25, v25, v25 row_half_mirror row_mask:0xf bank_mask:0xf
  v_add_f32_dpp v26, v26, v26 row_half_mirror row_mask:0xf bank_mask:0xf
  v_add_f32_dpp v27, v27, v27 row_half_mirror row_mask:0xf bank_mask:0xf
  v_add_f32_dpp v28, v28, v28 row_half_mirror row_mask:0xf bank_mask:0xf
  v_add_f32_dpp v29, v29, v29 row_half_mirror row_mask:0xf bank_mask:0xf
  v_add_f32_dpp v30, v30, v30 row_half_mirror row_mask:0xf bank_mask:0xf
  v_add_f32_dpp v31, v31, v31 row_half_mirror row_mask:0xf bank_mask:0xf
  v_add_f32_dpp v32, v32, v32 row_half_mirror row_mask:0xf bank_mask:0xf
  v_add_f32_dpp v33, v33, v33 row_half_mirror row_mask:0xf bank_mask:0xf
  v_add_f32_dpp v34, v34, v34 row_half_mirror row_mask:0xf bank_mask:0xf
  v_add_f32_dpp v35, v35, v35 row_half_mirror row_mask:0xf bank_mask:0xf
  s_mov_b32 s70, 0x3d93cd3a
  v_cvt_pk_bf16_f32 v40, v20, v21
  v_cvt_pk_bf16_f32 v41, v22, v23
  v_cvt_pk_bf16_f32 v42, v24, v25
  v_cvt_pk_bf16_f32 v43, v26, v27
  v_cvt_pk_bf16_f32 v44, v28, v29
  v_cvt_pk_bf16_f32 v45, v30, v31
  v_cvt_pk_bf16_f32 v46, v32, v33
  v_cvt_pk_bf16_f32 v47, v34, v35
  v_lshlrev_b32 v20, 16, v40
  v_and_b32 v21, s68, v40
  v_lshlrev_b32 v22, 16, v41
  v_and_b32 v23, s68, v41
  v_lshlrev_b32 v24, 16, v42
  v_and_b32 v25, s68, v42
  v_lshlrev_b32 v26, 16, v43
  v_and_b32 v27, s68, v43
  v_lshlrev_b32 v28, 16, v44
  v_and_b32 v29, s68, v44
  v_lshlrev_b32 v30, 16, v45
  v_and_b32 v31, s68, v45
  v_lshlrev_b32 v32, 16, v46
  v_and_b32 v33, s68, v46
  v_lshlrev_b32 v34, 16, v47
  v_and_b32 v35, s68, v47
  v_mul_f32 v20, s70, v20
  v_mul_f32 v21, s70, v21
  v_mul_f32 v22, s70, v22
  v_mul_f32 v23, s70, v23
  v_mul_f32 v24, s70, v24
  v_mul_f32 v25, s70, v25
  v_mul_f32 v26, s70, v26
  v_mul_f32 v27, s70, v27
  v_mul_f32 v28, s70, v28
  v_mul_f32 v29, s70, v29
  v_mul_f32 v30, s70, v30
  v_mul_f32 v31, s70, v31
  v_mul_f32 v32, s70, v32
  v_mul_f32 v33, s70, v33
  v_mul_f32 v34, s70, v34
  v_mul_f32 v35, s70, v35
  v_cvt_pk_bf16_f32 v40, v20, v21
  v_cvt_pk_bf16_f32 v41, v22, v23
  v_cvt_pk_bf16_f32 v42, v24, v25
  v_cvt_pk_bf16_f32 v43, v26, v27
  v_cvt_pk_bf16_f32 v44, v28, v29
  v_cvt_pk_bf16_f32 v45, v30, v31
  v_cvt_pk_bf16_f32 v46, v32, v33
  v_cvt_pk_bf16_f32 v47, v34, v35
  v_lshlrev_b32 v20, 16, v40
  v_and_b32 v21, s68, v40
  v_lshlrev_b32 v22, 16, v41
  v_and_b32 v23, s68, v41
  v_lshlrev_b32 v24, 16, v42
  v_and_b32 v25, s68, v42
  v_lshlrev_b32 v26, 16, v43
  v_and_b32 v27, s68, v43
  v_lshlrev_b32 v28, 16, v44
  v_and_b32 v29, s68, v44
  v_lshlrev_b32 v30, 16, v45
  v_and_b32 v31, s68, v45
  v_lshlrev_b32 v32, 16, v46
  v_and_b32 v33, s68, v46
  v_lshlrev_b32 v34, 16, v47
  v_and_b32 v35, s68, v47
  v_max3_f32 v2, v20, v21, v22
  v_max3_f32 v3, v23, v24, v25
  v_max3_f32 v2, v2, v26, v27
  v_max3_f32 v3, v3, v28, v29
  v_max3_f32 v2, v2, v30, v31
  v_max3_f32 v3, v3, v32, v33
  v_max3_f32 v2, v2, v34, v35
  v_max_f32 v2, v2, v3
  s_nop 1
  v_max_f32_dpp v2, v2, v2 row_ror:8 row_mask:0xf bank_mask:0xf
  v_mov_b32 v3, v2
  s_nop 1
  v_permlane16_swap_b32 v2, v3
  v_max_f32 v2, v2, v3
  v_mov_b32 v3, v2
  s_nop 1
  v_permlane32_swap_b32 v2, v3
  v_max_f32 v2, v2, v3
  s_lshl_b32 s69, s60, 2
  v_mov_b32 v3, s69
  v_mov_b32 v4, 1
  s_waitcnt vmcnt(0)
  s_mov_b64 exec, 1
  ds_write_b32 v3, v2 offset:384
  ds_add_u32 v5, v4 offset:420
  s_mov_b64 exec, -1
  s_cmp_lt_u32 s60, 4
  s_cselect_b64 vcc, -1, 0
  s_cselect_b32 s70, 8, 4
  s_cselect_b32 s71, 0, 16
L_spinm:
  ds_read_b32 v2, v5 offset:420
  s_waitcnt lgkmcnt(0)
  v_readfirstlane_b32 s69, v2
  s_nop 0
  s_cmp_ge_u32 s69, s70
  s_cbranch_scc1 L_spinm_ok
  s_sleep 2
  s_add_u32 s0, s0, 1
  s_cmp_lt_u32 s0, 200000
  s_cbranch_scc1 L_spinm
  s_branch L_fin
L_spinm_ok:
  v_mov_b32 v3, s71
  ds_read_b128 v[40:43], v3 offset:384
  ds_read_b128 v[44:47], v5 offset:400
  s_mov_b32 s70, 0x3fb8aa3b
  s_waitcnt lgkmcnt(0)
  v_max3_f32 v17, v40, v41, v42
  v_max3_f32 v3, v43, v44, v45
  v_max3_f32 v17, v17, v46, v47
  v_max_f32 v17, v17, v3
  v_sub_f32 v20, v20, v17
  v_sub_f32 v21, v21, v17
  v_sub_f32 v22, v22, v17
  v_sub_f32 v23, v23, v17
  v_sub_f32 v24, v24, v17
  v_sub_f32 v25, v25, v17
  v_sub_f32 v26, v26, v17
  v_sub_f32 v27, v27, v17
  v_sub_f32 v28, v28, v17
  v_sub_f32 v29, v29, v17
  v_sub_f32 v30, v30, v17
  v_sub_f32 v31, v31, v17
  v_sub_f32 v32, v32, v17
  v_sub_f32 v33, v33, v17
  v_sub_f32 v34, v34, v17
  v_sub_f32 v35, v35, v17
  v_mul_f32 v20, s70, v20
  v_mul_f32 v21, s70, v21
  v_mul_f32 v22, s70, v22
  v_mul_f32 v23, s70, v23
  v_mul_f32 v24, s70, v24
  v_mul_f32 v25, s70, v25
  v_mul_f32 v26, s70, v26
  v_mul_f32 v27, s70, v27
  v_mul_f32 v28, s70, v28
  v_mul_f32 v29, s70, v29
  v_mul_f32 v30, s70, v30
  v_mul_f32 v31, s70, v31
  v_mul_f32 v32, s70, v32
  v_mul_f32 v33, s70, v33
  v_mul_f32 v34, s70, v34
  v_mul_f32 v35, s70, v35
  v_exp_f32 v20, v20
  v_exp_f32 v21, v21
  v_exp_f32 v22, v22
  v_exp_f32 v23, v23
  v_exp_f32 v24, v24
  v_exp_f32 v25, v25
  v_exp_f32 v26, v26
  v_exp_f32 v27, v27
  v_exp_f32 v28, v28
  v_exp_f32 v29, v29
  v_exp_f32 v30, v30
  v_exp_f32 v31, v31
  v_exp_f32 v32, v32
  v_exp_f32 v33, v33
  v_exp_f32 v34, v34
  v_exp_f32 v35, v35
  v_pk_add_f32 v[40:41], v[20:21], v[22:23]
  v_pk_add_f32 v[42:43], v[24:25], v[26:27]
  v_pk_add_f32 v[44:45], v[28:29], v[30:31]
  v_pk_add_f32 v[46:47], v[32:33], v[34:35]
  v_pk_add_f32 v[40:41], v[40:41], v[42:43]
  v_pk_add_f32 v[44:45], v[44:45], v[46:47]
  v_pk_add_f32 v[40:41], v[40:41], v[44:45]
  v_add_f32 v14, v40, v41
  v_cvt_pk_bf16_f32 v20, v20, v20
  v_cvt_pk_bf16_f32 v21, v21, v21
  v_cvt_pk_bf16_f32 v22, v22, v22
  v_cvt_pk_bf16_f32 v23, v23, v23
  v_cvt_pk_bf16_f32 v24, v24, v24
  v_cvt_pk_bf16_f32 v25, v25, v25
  v_cvt_pk_bf16_f32 v26, v26, v26
  v_cvt_pk_bf16_f32 v27, v27, v27
  v_cvt_pk_bf16_f32 v28, v28, v28
  v_cvt_pk_bf16_f32 v29, v29, v29
  v_cvt_pk_bf16_f32 v30, v30, v30
  v_cvt_pk_bf16_f32 v31, v31, v31
  v_cvt_pk_bf16_f32 v32, v32, v32
  v_cvt_pk_bf16_f32 v33, v33, v33
  v_cvt_pk_bf16_f32 v34, v34, v34
  v_cvt_pk_bf16_f32 v35, v35, v35
  v_add_f32_dpp v14, v14, v14 row_ror:8 row_mask:0xf bank_mask:0xf
  v_mov_b32 v4, v14
  s_nop 1
  v_permlane16_swap_b32 v14, v4
  v_add_f32 v14, v14, v4
  v_mov_b32 v4, v14
  s_nop 1
  v_permlane32_swap_b32 v14, v4
  v_add_f32 v14, v14, v4
  s_mul_i32 s69, s60, 1792
  v_mul_u32_u24 v13, 896, v0
  v_add_u32 v13, s69, v13
  v_mov_b32 v15, v17
  s_cmp_lg_u32 s60, 0
  s_cselect_b64 exec, 3, 2
  v_mov_b32 v15, 0
  s_mov_b64 exec, 2
  v_mov_b32 v14, 0
  s_mov_b64 exec, 3
  ds_write_b64 v13, v[14:15] offset:3552
  s_mov_b64 exec, -1
  v_lshrrev_b32 v4, 5, v0
  v_mul_u32_u24 v4, 896, v4
  v_lshl_add_u32 v4, v6, 4, v4
  v_bfe_u32 v7, v0, 4, 1
  v_lshl_add_u32 v4, v7, 7, v4
  v_add_u32 v4, s69, v4
  s_min_u32 s69, s15, 4
  s_lshl_b32 s70, s69, 5
  s_add_u32 s70, s70, 17024
  v_lshrrev_b32 v16, 4, v0
  v_bfe_u32 v2, v0, 2, 2
  v_and_b32 v3, 3, v0
  v_mul_u32_u24 v2, 160, v2
  v_lshl_add_u32 v2, v3, 3, v2
  v_add_u32 v2, s70, v2
  v_and_b32 v15, 1, v16
  v_mul_u32_u24 v15, 1280, v15
  v_add_u32 v15, v15, v2
  v_mul_u32_u24 v6, 1280, v16
  v_add_u32 v2, v6, v2
  v_mov_b32 v11, v2
  v_mov_b32 v12, v15
  v_mul_u32_u24 v6, 576, v3
  v_lshl_add_u32 v6, v16, 4, v6
  s_mul_i32 s79, s64, 40960
  s_add_u32 s79, s79, 1048576
  v_lshrrev_b32 v7, 1, v3
  v_lshlrev_b32 v7, 12, v7
  v_and_b32 v15, 1, v0
  v_lshl_add_u32 v7, v15, 6, v7
  v_lshl_add_u32 v7, v16, 4, v7
  s_lshl_b32 s70, s65, 7
  s_add_u32 s76, s79, s70
  s_lshl_b32 s70, s69, 13
  s_add_u32 s76, s76, s70
  s_lshl1_add_u32 s70, s66, s67
  s_lshl3_add_u32 s71, s65, s70
  s_lshl_b32 s71, s71, 10
  s_add_u32 s71, s71, 786432
  s_min_u32 s78, s15, 3
  s_lshl2_add_u32 s77, s65, s78
  s_lshl_b32 s77, s77, 11
  s_add_u32 s77, s77, 786432
  v_lshlrev_b32 v2, 4, v0
  s_mul_i32 s70, s78, 576
  v_lshlrev_b32 v3, 3, v0
  v_add_u32 v3, s70, v3
  v_mov_b32 v8, 1.0
  v_mov_b32 v9, 0
  v_mov_b32 v18, 0xffffff00
  v_mov_b32 v19, 0x3fb8aa3b
  v_mov_b32 v9, v2
  s_mov_b32 exec_hi, 0xffff
  v_and_b32 v9, 0x300, v2
  v_and_b32 v10, 1, v0
  v_lshl_add_u32 v9, v10, 7, v9
  v_bfe_u32 v10, v0, 1, 3
  v_lshl_add_u32 v9, v10, 4, v9
  s_mov_b32 exec_hi, -1
  s_cmp_eq_u32 s15, 5
  s_cbranch_scc1 L_red0
L_red0_done:
  s_setprio 0
  s_cbranch_vccnz L_vissue
  s_setprio 1
L_vissue:
  s_waitcnt lgkmcnt(0)
  s_barrier
  ds_read_b32 v10, v5 offset:428
  s_mov_b32 s75, s3
  s_mul_i32 s69, s75, 3072
  buffer_load_dwordx4 v[64:67], v1, s[32:35], s69 offen offset:0 nt
  buffer_load_dwordx4 v[68:71], v1, s[32:35], s69 offen offset:128 nt
  buffer_load_dwordx4 v[72:75], v1, s[32:35], s69 offen offset:256 nt
  s_waitcnt lgkmcnt(0)
  v_readfirstlane_b32 s74, v10
  ds_read_b32 v10, v5 offset:428
  s_cmp_eq_u32 s74, 3
  s_cbranch_scc1 L_pr3
  s_cmp_lg_u32 s74, 2
  s_cbranch_scc1 L_pr3
  s_waitcnt vmcnt(0)
L_pr3:
  s_add_u32 s75, s75, 88
  s_and_b32 s75, s75, 255
  s_mul_i32 s69, s75, 3072
  buffer_load_dwordx4 v[76:79], v1, s[32:35], s69 offen offset:0 nt
  buffer_load_dwordx4 v[80:83], v1, s[32:35], s69 offen offset:128 nt
  buffer_load_dwordx4 v[84:87], v1, s[32:35], s69 offen offset:256 nt
  s_waitcnt lgkmcnt(0)
  v_readfirstlane_b32 s74, v10
  ds_read_b32 v10, v5 offset:428
  s_cmp_eq_u32 s74, 3
  s_cbranch_scc1 L_pr4
  s_waitcnt vmcnt(3)
  s_cmp_lg_u32 s74, 2
  s_cbranch_scc1 L_pr4
  s_waitcnt vmcnt(0)
L_pr4:
  s_add_u32 s75, s75, 88
  s_and_b32 s75, s75, 255
  s_mul_i32 s69, s75, 3072
  buffer_load_dwordx4 v[88:91], v1, s[32:35], s69 offen offset:0 nt
  buffer_load_dwordx4 v[92:95], v1, s[32:35], s69 offen offset:128 nt
  buffer_load_dwordx4 v[96:99], v1, s[32:35], s69 offen offset:256 nt
  s_waitcnt lgkmcnt(0)
  v_readfirstlane_b32 s74, v10
  ds_read_b32 v10, v5 offset:428
  s_cmp_eq_u32 s74, 3
  s_cbranch_scc1 L_pr5
  s_waitcnt vmcnt(3)
  s_cmp_lg_u32 s74, 2
  s_cbranch_scc1 L_pr5
  s_waitcnt vmcnt(0)
L_pr5:
  s_add_u32 s75, s75, 88
  s_and_b32 s75, s75, 255
  s_mul_i32 s69, s75, 3072
  buffer_load_dwordx4 v[100:103], v1, s[32:35], s69 offen offset:0 nt
  buffer_load_dwordx4 v[104:107], v1, s[32:35], s69 offen offset:128 nt
  buffer_load_dwordx4 v[108:111], v1, s[32:35], s69 offen offset:256 nt
  s_waitcnt lgkmcnt(0)
  v_readfirstlane_b32 s74, v10
  ds_read_b32 v10, v5 offset:428
  s_cmp_eq_u32 s74, 3
  s_cbranch_scc1 L_pr6
  s_waitcnt vmcnt(3)
  s_cmp_lg_u32 s74, 2
  s_cbranch_scc1 L_pr6
  s_waitcnt vmcnt(0)
L_pr6:
  s_add_u32 s75, s75, 88
  s_and_b32 s75, s75, 255
  s_mul_i32 s69, s75, 3072
  buffer_load_dwordx4 v[112:115], v1, s[32:35], s69 offen offset:0 nt
  buffer_load_dwordx4 v[116:119], v1, s[32:35], s69 offen offset:128 nt
  buffer_load_dwordx4 v[120:123], v1, s[32:35], s69 offen offset:256 nt
  v_and_b32 v40, v20, v36
  v_and_b32 v41, v20, v37
  v_and_b32 v42, v20, v38
  v_and_b32 v43, v20, v39
  s_nop 0
  s_waitcnt vmcnt(12)
  v_mfma_f32_16x16x32_bf16 v[48:51], v[40:43], v[64:67], 0
  v_mfma_f32_16x16x32_bf16 v[52:55], v[40:43], v[68:71], 0
  v_mfma_f32_16x16x32_bf16 v[56:59], v[40:43], v[72:75], 0
  s_waitcnt lgkmcnt(0)
  v_readfirstlane_b32 s74, v10
  ds_read_b32 v10, v5 offset:428
  s_cmp_eq_u32 s74, 3
  s_cbranch_scc1 L_pr7
  s_waitcnt vmcnt(3)
  s_cmp_lg_u32 s74, 2
  s_cbranch_scc1 L_pr7
  s_waitcnt vmcnt(0)
L_pr7:
  s_add_u32 s75, s75, 88
  s_and_b32 s75, s75, 255
  s_mul_i32 s69, s75, 3072
  buffer_load_dwordx4 v[124:127], v1, s[32:35], s69 offen offset:0 nt
  buffer_load_dwordx4 v[128:131], v1, s[32:35], s69 offen offset:128 nt
  buffer_load_dwordx4 v[132:135], v1, s[32:35], s69 offen offset:256 nt
  v_and_b32 v44, v21, v36
  v_and_b32 v45, v21, v37
  v_and_b32 v46, v21, v38
  v_and_b32 v47, v21, v39
  s_nop 0
  s_waitcnt vmcnt(12)
  v_mfma_f32_16x16x32_bf16 v[48:51], v[44:47], v[76:79], v[48:51]
  v_mfma_f32_16x16x32_bf16 v[52:55], v[44:47], v[80:83], v[52:55]
  v_mfma_f32_16x16x32_bf16 v[56:59], v[44:47], v[84:87], v[56:59]
  s_waitcnt lgkmcnt(0)
  v_readfirstlane_b32 s74, v10
  ds_read_b32 v10, v5 offset:428
  s_cmp_eq_u32 s74, 3
  s_cbranch_scc1 L_pr8
  s_waitcnt vmcnt(3)
  s_cmp_lg_u32 s74, 2
  s_cbranch_scc1 L_pr8
  s_waitcnt vmcnt(0)
L_pr8:
  s_add_u32 s75, s75, 88
  s_and_b32 s75, s75, 255
  s_mul_i32 s69, s75, 3072
  buffer_load_dwordx4 v[136:139], v1, s[32:35], s69 offen offset:0 nt
  buffer_load_dwordx4 v[140:143], v1, s[32:35], s69 offen offset:128 nt
  buffer_load_dwordx4 v[144:147], v1, s[32:35], s69 offen offset:256 nt
  v_and_b32 v40, v22, v36
  v_and_b32 v41, v22, v37
  v_and_b32 v42, v22, v38
  v_and_b32 v43, v22, v39
  s_nop 0
  s_waitcnt vmcnt(12)
  v_mfma_f32_16x16x32_bf16 v[48:51], v[40:43], v[88:91], v[48:51]
  v_mfma_f32_16x16x32_bf16 v[52:55], v[40:43], v[92:95], v[52:55]
  v_mfma_f32_16x16x32_bf16 v[56:59], v[40:43], v[96:99], v[56:59]
  s_waitcnt lgkmcnt(0)
  v_readfirstlane_b32 s74, v10
  ds_read_b32 v10, v5 offset:428
  s_cmp_eq_u32 s74, 3
  s_cbranch_scc1 L_pr9
  s_waitcnt vmcnt(3)
  s_cmp_lg_u32 s74, 2
  s_cbranch_scc1 L_pr9
  s_waitcnt vmcnt(0)
L_pr9:
  s_add_u32 s75, s75, 88
  s_and_b32 s75, s75, 255
  s_mul_i32 s69, s75, 3072
  buffer_load_dwordx4 v[148:151], v1, s[32:35], s69 offen offset:0 nt
  buffer_load_dwordx4 v[152:155], v1, s[32:35], s69 offen offset:128 nt
  buffer_load_dwordx4 v[156:159], v1, s[32:35], s69 offen offset:256 nt
  v_and_b32 v44, v23, v36
  v_and_b32 v45, v23, v37
  v_and_b32 v46, v23, v38
  v_and_b32 v47, v23, v39
  s_nop 0
  s_waitcnt vmcnt(12)
  v_mfma_f32_16x16x32_bf16 v[48:51], v[44:47], v[100:103], v[48:51]
  v_mfma_f32_16x16x32_bf16 v[52:55], v[44:47], v[104:107], v[52:55]
  v_mfma_f32_16x16x32_bf16 v[56:59], v[44:47], v[108:111], v[56:59]
  s_waitcnt lgkmcnt(0)
  v_readfirstlane_b32 s74, v10
  ds_read_b32 v10, v5 offset:428
  s_cmp_eq_u32 s74, 3
  s_cbranch_scc1 L_pr10
  s_waitcnt vmcnt(3)
  s_cmp_lg_u32 s74, 2
  s_cbranch_scc1 L_pr10
  s_waitcnt vmcnt(0)
L_pr10:
  s_add_u32 s75, s75, 88
  s_and_b32 s75, s75, 255
  s_mul_i32 s69, s75, 3072
  buffer_load_dwordx4 v[160:163], v1, s[32:35], s69 offen offset:0 nt
  buffer_load_dwordx4 v[164:167], v1, s[32:35], s69 offen offset:128 nt
  buffer_load_dwordx4 v[168:171], v1, s[32:35], s69 offen offset:256 nt
  v_and_b32 v40, v24, v36
  v_and_b32 v41, v24, v37
  v_and_b32 v42, v24, v38
  v_and_b32 v43, v24, v39
  s_nop 0
  s_waitcnt vmcnt(12)
  v_mfma_f32_16x16x32_bf16 v[48:51], v[40:43], v[112:115], v[48:51]
  v_mfma_f32_16x16x32_bf16 v[52:55], v[40:43], v[116:119], v[52:55]
  v_mfma_f32_16x16x32_bf16 v[56:59], v[40:43], v[120:123], v[56:59]
  s_waitcnt lgkmcnt(0)
  v_readfirstlane_b32 s74, v10
  ds_read_b32 v10, v5 offset:428
  s_cmp_eq_u32 s74, 3
  s_cbranch_scc1 L_pr11
  s_waitcnt vmcnt(3)
  s_cmp_lg_u32 s74, 2
  s_cbranch_scc1 L_pr11
  s_waitcnt vmcnt(0)
L_pr11:
  s_add_u32 s75, s75, 88
  s_and_b32 s75, s75, 255
  s_mul_i32 s69, s75, 3072
  buffer_load_dwordx4 v[172:175], v1, s[32:35], s69 offen offset:0 nt
  buffer_load_dwordx4 v[176:179], v1, s[32:35], s69 offen offset:128 nt
  buffer_load_dwordx4 v[180:183], v1, s[32:35], s69 offen offset:256 nt
  v_and_b32 v44, v25, v36
  v_and_b32 v45, v25, v37
  v_and_b32 v46, v25, v38
  v_and_b32 v47, v25, v39
  s_nop 0
  s_waitcnt vmcnt(12)
  v_mfma_f32_16x16x32_bf16 v[48:51], v[44:47], v[124:127], v[48:51]
  v_mfma_f32_16x16x32_bf16 v[52:55], v[44:47], v[128:131], v[52:55]
  v_mfma_f32_16x16x32_bf16 v[56:59], v[44:47], v[132:135], v[56:59]
  s_waitcnt lgkmcnt(0)
  v_readfirstlane_b32 s74, v10
  ds_read_b32 v10, v5 offset:428
  s_cmp_eq_u32 s74, 3
  s_cbranch_scc1 L_pr12
  s_waitcnt vmcnt(3)
  s_cmp_lg_u32 s74, 2
  s_cbranch_scc1 L_pr12
  s_waitcnt vmcnt(0)
L_pr12:
  s_add_u32 s75, s75, 88
  s_and_b32 s75, s75, 255
  s_mul_i32 s69, s75, 3072
  buffer_load_dwordx4 v[184:187], v1, s[32:35], s69 offen offset:0 nt
  buffer_load_dwordx4 v[188:191], v1, s[32:35], s69 offen offset:128 nt
  buffer_load_dwordx4 v[192:195], v1, s[32:35], s69 offen offset:256 nt
  v_and_b32 v40, v26, v36
  v_and_b32 v41, v26, v37
  v_and_b32 v42, v26, v38
  v_and_b32 v43, v26, v39
  s_nop 0
  s_waitcnt vmcnt(12)
  v_mfma_f32_16x16x32_bf16 v[48:51], v[40:43], v[136:139], v[48:51]
  v_mfma_f32_16x16x32_bf16 v[52:55], v[40:43], v[140:143], v[52:55]
  v_mfma_f32_16x16x32_bf16 v[56:59], v[40:43], v[144:147], v[56:59]
  s_waitcnt lgkmcnt(0)
  v_readfirstlane_b32 s74, v10
  ds_read_b32 v10, v5 offset:428
  s_cmp_eq_u32 s74, 3
  s_cbranch_scc1 L_pr13
  s_waitcnt vmcnt(3)
  s_cmp_lg_u32 s74, 2
  s_cbranch_scc1 L_pr13
  s_waitcnt vmcnt(0)
L_pr13:
  s_add_u32 s75, s75, 88
  s_and_b32 s75, s75, 255
  s_mul_i32 s69, s75, 3072
  buffer_load_dwordx4 v[196:199], v1, s[32:35], s69 offen offset:0 nt
  buffer_load_dwordx4 v[200:203], v1, s[32:35], s69 offen offset:128 nt
  buffer_load_dwordx4 v[204:207], v1, s[32:35], s69 offen offset:256 nt
  v_and_b32 v44, v27, v36
  v_and_b32 v45, v27, v37
  v_and_b32 v46, v27, v38
  v_and_b32 v47, v27, v39
  s_nop 0
  s_waitcnt vmcnt(12)
  v_mfma_f32_16x16x32_bf16 v[48:51], v[44:47], v[148:151], v[48:51]
  v_mfma_f32_16x16x32_bf16 v[52:55], v[44:47], v[152:155], v[52:55]
  v_mfma_f32_16x16x32_bf16 v[56:59], v[44:47], v[156:159], v[56:59]
  s_waitcnt lgkmcnt(0)
  v_readfirstlane_b32 s74, v10
  ds_read_b32 v10, v5 offset:428
  s_cmp_eq_u32 s74, 3
  s_cbranch_scc1 L_pr14
  s_waitcnt vmcnt(3)
  s_cmp_lg_u32 s74, 2
  s_cbranch_scc1 L_pr14
  s_waitcnt vmcnt(0)
L_pr14:
  s_add_u32 s75, s75, 88
  s_and_b32 s75, s75, 255
  s_mul_i32 s69, s75, 3072
  buffer_load_dwordx4 v[208:211], v1, s[32:35], s69 offen offset:0 nt
  buffer_load_dwordx4 v[212:215], v1, s[32:35], s69 offen offset:128 nt
  buffer_load_dwordx4 v[216:219], v1, s[32:35], s69 offen offset:256 nt
  v_and_b32 v40, v28, v36
  v_and_b32 v41, v28, v37
  v_and_b32 v42, v28, v38
  v_and_b32 v43, v28, v39
  s_nop 0
  s_waitcnt vmcnt(12)
  v_mfma_f32_16x16x32_bf16 v[48:51], v[40:43], v[160:163], v[48:51]
  v_mfma_f32_16x16x32_bf16 v[52:55], v[40:43], v[164:167], v[52:55]
  v_mfma_f32_16x16x32_bf16 v[56:59], v[40:43], v[168:171], v[56:59]
  s_waitcnt lgkmcnt(0)
  v_readfirstlane_b32 s74, v10
  s_nop 0
  s_cmp_eq_u32 s74, 3
  s_cbranch_scc1 L_pr15
  s_waitcnt vmcnt(3)
  s_cmp_lg_u32 s74, 2
  s_cbranch_scc1 L_pr15
  s_waitcnt vmcnt(0)
L_pr15:
  s_add_u32 s75, s75, 88
  s_and_b32 s75, s75, 255
  s_mul_i32 s69, s75, 3072
  buffer_load_dwordx4 v[220:223], v1, s[32:35], s69 offen offset:0 nt
  buffer_load_dwordx4 v[224:227], v1, s[32:35], s69 offen offset:128 nt
  buffer_load_dwordx4 v[228:231], v1, s[32:35], s69 offen offset:256 nt
  v_and_b32 v44, v29, v36
  v_and_b32 v45, v29, v37
  v_and_b32 v46, v29, v38
  v_and_b32 v47, v29, v39
  s_nop 0
  s_waitcnt vmcnt(12)
  v_mfma_f32_16x16x32_bf16 v[48:51], v[44:47], v[172:175], v[48:51]
  v_mfma_f32_16x16x32_bf16 v[52:55], v[44:47], v[176:179], v[52:55]
  v_mfma_f32_16x16x32_bf16 v[56:59], v[44:47], v[180:183], v[56:59]
  s_cbranch_vccnz L_pr16
  s_waitcnt vmcnt(3)
  s_cmp_lg_u32 s74, 2
  s_cbranch_scc1 L_pr16
  s_waitcnt vmcnt(0)
L_pr16:
  s_add_u32 s75, s75, 88
  s_and_b32 s75, s75, 255
  s_mul_i32 s69, s75, 3072
  buffer_load_dwordx4 v[232:235], v1, s[32:35], s69 offen offset:0 nt
  buffer_load_dwordx4 v[236:239], v1, s[32:35], s69 offen offset:128 nt
  buffer_load_dwordx4 v[240:243], v1, s[32:35], s69 offen offset:256 nt
  v_and_b32 v40, v30, v36
  v_and_b32 v41, v30, v37
  v_and_b32 v42, v30, v38
  v_and_b32 v43, v30, v39
  s_nop 0
  s_waitcnt vmcnt(12)
  v_mfma_f32_16x16x32_bf16 v[48:51], v[40:43], v[184:187], v[48:51]
  v_mfma_f32_16x16x32_bf16 v[52:55], v[40:43], v[188:191], v[52:55]
  v_mfma_f32_16x16x32_bf16 v[56:59], v[40:43], v[192:195], v[56:59]
  s_cbranch_vccnz L_pr17
  s_waitcnt vmcnt(3)
  s_cmp_lg_u32 s74, 2
  s_cbranch_scc1 L_pr17
  s_waitcnt vmcnt(0)
L_pr17:
  s_add_u32 s75, s75, 88
  s_and_b32 s75, s75, 255
  s_mul_i32 s69, s75, 3072
  buffer_load_dwordx4 v[244:247], v1, s[32:35], s69 offen offset:0 nt
  buffer_load_dwordx4 v[248:251], v1, s[32:35], s69 offen offset:128 nt
  buffer_load_dwordx4 v[252:255], v1, s[32:35], s69 offen offset:256 nt
  s_cbranch_vccnz L_nogate3
  s_barrier
  s_cmp_eq_u32 s60, 6
  s_cbranch_scc1 L_rank2
L_nogate3:
  ds_read_b64_tr_b16 v[64:65], v11 offset:0
  ds_read_b64_tr_b16 v[66:67], v11 offset:640
  ds_read_b64_tr_b16 v[68:69], v11 offset:5120
  ds_read_b64_tr_b16 v[70:71], v11 offset:5760
  ds_read_b64_tr_b16 v[72:73], v11 offset:10240
  ds_read_b64_tr_b16 v[74:75], v11 offset:10880
  ds_read_b64_tr_b16 v[76:77], v11 offset:15360
  ds_read_b64_tr_b16 v[78:79], v11 offset:16000
  ds_read_b64_tr_b16 v[80:81], v11 offset:20480
  ds_read_b64_tr_b16 v[82:83], v11 offset:21120
  ds_read_b64_tr_b16 v[84:85], v11 offset:25600
  ds_read_b64_tr_b16 v[86:87], v11 offset:26240
  ds_read_b64_tr_b16 v[88:89], v11 offset:30720
  ds_read_b64_tr_b16 v[90:91], v11 offset:31360
  ds_read_b64_tr_b16 v[92:93], v12 offset:35840
  ds_read_b64_tr_b16 v[94:95], v12 offset:36480
  v_and_b32 v44, v31, v36
  v_and_b32 v45, v31, v37
  v_and_b32 v46, v31, v38
  v_and_b32 v47, v31, v39
  s_nop 0
  s_waitcnt vmcnt(12)
  v_mfma_f32_16x16x32_bf16 v[48:51], v[44:47], v[196:199], v[48:51]
  v_mfma_f32_16x16x32_bf16 v[52:55], v[44:47], v[200:203], v[52:55]
  v_mfma_f32_16x16x32_bf16 v[56:59], v[44:47], v[204:207], v[56:59]
  v_and_b32 v40, v32, v36
  v_and_b32 v41, v32, v37
  v_and_b32 v42, v32, v38
  v_and_b32 v43, v32, v39
  s_nop 0
  s_waitcnt vmcnt(9)
  v_mfma_f32_16x16x32_bf16 v[48:51], v[40:43], v[208:211], v[48:51]
  v_mfma_f32_16x16x32_bf16 v[52:55], v[40:43], v[212:215], v[52:55]
  v_mfma_f32_16x16x32_bf16 v[56:59], v[40:43], v[216:219], v[56:59]
  v_and_b32 v44, v33, v36
  v_and_b32 v45, v33, v37
  v_and_b32 v46, v33, v38
  v_and_b32 v47, v33, v39
  s_nop 0
  s_waitcnt vmcnt(6)
  v_mfma_f32_16x16x32_bf16 v[48:51], v[44:47], v[220:223], v[48:51]
  v_mfma_f32_16x16x32_bf16 v[52:55], v[44:47], v[224:227], v[52:55]
  v_mfma_f32_16x16x32_bf16 v[56:59], v[44:47], v[228:231], v[56:59]
  v_and_b32 v40, v34, v36
  v_and_b32 v41, v34, v37
  v_and_b32 v42, v34, v38
  v_and_b32 v43, v34, v39
  s_nop 0
  s_waitcnt vmcnt(3)
  v_mfma_f32_16x16x32_bf16 v[48:51], v[40:43], v[232:235], v[48:51]
  v_mfma_f32_16x16x32_bf16 v[52:55], v[40:43], v[236:239], v[52:55]
  v_mfma_f32_16x16x32_bf16 v[56:59], v[40:43], v[240:243], v[56:59]
  v_and_b32 v44, v35, v36
  v_and_b32 v45, v35, v37
  v_and_b32 v46, v35, v38
  v_and_b32 v47, v35, v39
  s_nop 0
  s_waitcnt vmcnt(0)
  v_mfma_f32_16x16x32_bf16 v[48:51], v[44:47], v[244:247], v[48:51]
  v_mfma_f32_16x16x32_bf16 v[52:55], v[44:47], v[248:251], v[52:55]
  v_mfma_f32_16x16x32_bf16 v[56:59], v[44:47], v[252:255], v[56:59]
  s_cbranch_vccnz L_noresc
  ds_read_b128 v[24:27], v5 offset:384
  ds_read_b128 v[28:31], v5 offset:400
  s_waitcnt lgkmcnt(0)
  v_max3_f32 v10, v24, v25, v26
  v_max3_f32 v15, v27, v28, v29
  v_max3_f32 v10, v10, v30, v31
  v_max_f32 v10, v10, v15
  v_sub_f32 v16, v17, v10
  v_mul_f32 v16, v19, v16
  v_exp_f32 v16, v16
  s_mov_b32 exec_lo, 0x0
  s_mov_b32 exec_hi, 0x800000
  v_mov_b32 v60, v10
  s_mov_b64 exec, -1
  v_mul_f32 v14, v16, v14
  v_pk_mul_f32 v[48:49], v[48:49], v[16:17] op_sel_hi:[1,0]
  v_pk_mul_f32 v[50:51], v[50:51], v[16:17] op_sel_hi:[1,0]
  v_pk_mul_f32 v[52:53], v[52:53], v[16:17] op_sel_hi:[1,0]
  v_pk_mul_f32 v[54:55], v[54:55], v[16:17] op_sel_hi:[1,0]
  v_pk_mul_f32 v[56:57], v[56:57], v[16:17] op_sel_hi:[1,0]
  v_pk_mul_f32 v[58:59], v[58:59], v[16:17] op_sel_hi:[1,0]
  s_mov_b64 exec, 3
  ds_write_b32 v13, v14 offset:3552
L_noresc:
  s_mov_b32 exec_lo, 0xff00ff
  s_mov_b32 exec_hi, 0xff00ff00
  s_nop 4
  ds_write_b128 v4, v[48:51] offset:2688
  ds_write_b128 v4, v[52:55] offset:2944
  ds_write_b128 v4, v[56:59] offset:3200
  s_cmp_lt_u32 s60, 4
  s_cbranch_scc1 L_nops
  s_mov_b64 exec, 1
  v_mov_b32 v10, 1
  ds_add_u32 v5, v10 offset:444
  s_cmp_lg_u32 s60, 7
  s_cbranch_scc1 L_nops
L_spinps:
  ds_read_b32 v10, v5 offset:444
  s_waitcnt lgkmcnt(0)
  v_readfirstlane_b32 s69, v10
  s_nop 0
  s_cmp_eq_u32 s69, 4
  s_cbranch_scc1 L_spinps_ok
  s_sleep 2
  s_add_u32 s0, s0, 1
  s_cmp_lt_u32 s0, 200000
  s_cbranch_scc1 L_spinps
  s_branch L_fin
L_spinps_ok:
  s_mov_b32 exec_lo, 0xffffffff
  s_mov_b32 exec_hi, 0x40ffff
  ds_read_b128 v[136:139], v9 offset:9856
  ds_read_b128 v[140:143], v9 offset:10752
  ds_read_b128 v[144:147], v9 offset:11648
  ds_read_b128 v[148:151], v9 offset:12544
  ds_read_b128 v[152:155], v9 offset:13440
  ds_read_b128 v[156:159], v9 offset:14336
  ds_read_b128 v[160:163], v9 offset:15232
  ds_read_b128 v[164:167], v9 offset:16128
  s_waitcnt lgkmcnt(0)
  v_pk_add_f32 v[136:137], v[136:137], v[140:141]
  v_pk_add_f32 v[138:139], v[138:139], v[142:143]
  v_pk_add_f32 v[136:137], v[136:137], v[144:145]
  v_pk_add_f32 v[138:139], v[138:139], v[146:147]
  v_pk_add_f32 v[136:137], v[136:137], v[148:149]
  v_pk_add_f32 v[138:139], v[138:139], v[150:151]
  v_pk_add_f32 v[136:137], v[136:137], v[152:153]
  v_pk_add_f32 v[138:139], v[138:139], v[154:155]
  v_pk_add_f32 v[136:137], v[136:137], v[156:157]
  v_pk_add_f32 v[138:139], v[138:139], v[158:159]
  v_pk_add_f32 v[136:137], v[136:137], v[160:161]
  v_pk_add_f32 v[138:139], v[138:139], v[162:163]
  v_pk_add_f32 v[236:237], v[136:137], v[164:165]
  v_pk_add_f32 v[238:239], v[138:139], v[166:167]
L_nops:
  s_cmp_lg_u32 s60, 7
  s_mov_b32 exec_lo, 0xffffffff
  s_mov_b32 exec_hi, 0x40ffff
  s_waitcnt lgkmcnt(0)
  s_barrier
  s_cbranch_scc1 L_notgw
  ds_read_b128 v[136:139], v9 offset:2688
  ds_read_b128 v[140:143], v9 offset:3584
  ds_read_b128 v[144:147], v9 offset:4480
  ds_read_b128 v[148:151], v9 offset:5376
  ds_read_b128 v[152:155], v9 offset:6272
  ds_read_b128 v[156:159], v9 offset:7168
  ds_read_b128 v[160:163], v9 offset:8064
  ds_read_b128 v[164:167], v9 offset:8960
  s_waitcnt lgkmcnt(6)
  v_pk_add_f32 v[136:137], v[136:137], v[140:141]
  v_pk_add_f32 v[138:139], v[138:139], v[142:143]
  v_pk_add_f32 v[236:237], v[236:237], v[136:137]
  v_pk_add_f32 v[238:239], v[238:239], v[138:139]
  s_waitcnt lgkmcnt(4)
  v_pk_add_f32 v[144:145], v[144:145], v[148:149]
  v_pk_add_f32 v[146:147], v[146:147], v[150:151]
  v_pk_add_f32 v[236:237], v[236:237], v[144:145]
  v_pk_add_f32 v[238:239], v[238:239], v[146:147]
  s_waitcnt lgkmcnt(2)
  v_pk_add_f32 v[152:153], v[152:153], v[156:157]
  v_pk_add_f32 v[154:155], v[154:155], v[158:159]
  v_pk_add_f32 v[236:237], v[236:237], v[152:153]
  v_pk_add_f32 v[238:239], v[238:239], v[154:155]
  s_waitcnt lgkmcnt(0)
  v_pk_add_f32 v[160:161], v[160:161], v[164:165]
  v_pk_add_f32 v[162:163], v[162:163], v[166:167]
  v_pk_add_f32 v[60:61], v[236:237], v[160:161]
  v_pk_add_f32 v[62:63], v[238:239], v[162:163]
  s_mov_b32 exec_hi, 0x00ffffff
  v_and_or_b32 v60, v60, v18, s56
  v_and_or_b32 v61, v61, v18, s57
  v_and_or_b32 v62, v62, v18, s58
  v_and_or_b32 v63, v63, v18, s59
  s_add_u32 s69, s71, 917504
  buffer_store_dwordx4 v[60:63], v2, s[36:39], s69 offen
  buffer_store_dwordx4 v[60:63], v2, s[36:39], s71 offen sc1
  s_branch L_bar4
L_notgw:
  s_mov_b32 exec_hi, 0x00ffffff
  s_cmp_gt_u32 s15, 3
  s_cbranch_scc1 L_tw4
L_cons:
  s_add_u32 s71, s77, 917504
  s_mov_b32 s70, s71
  s_mov_b32 s69, 0
L_poll2:
  buffer_load_dwordx4 v[128:131], v2, s[36:39], s70 offen sc1
  buffer_load_dwordx4 v[132:135], v2, s[36:39], s70 offen offset:1024 sc1
  s_waitcnt vmcnt(1)
  v_xor_b32 v128, s56, v128
  v_xor_b32 v129, s57, v129
  v_xor_b32 v130, s58, v130
  v_xor_b32 v131, s59, v131
  v_or3_b32 v10, v128, v129, v130
  s_waitcnt vmcnt(0)
  v_xor_b32 v132, s56, v132
  v_xor_b32 v133, s57, v133
  v_xor_b32 v134, s58, v134
  v_xor_b32 v135, s59, v135
  v_or3_b32 v11, v132, v133, v134
  v_or3_b32 v10, v10, v131, v135
  v_or_b32 v10, v10, v11
  v_and_b32 v10, 0xff, v10
  v_cmp_ne_u32 vcc, 0, v10
  v_sub_f32 v20, v129, v133
  v_cvt_pk_bf16_f32 v14, v132, v133
  v_mul_f32 v20, v19, v20
  v_cvt_pk_bf16_f32 v15, v134, v135
  v_min_f32 v21, 0, v20
  v_min_f32_e64 v22, 0, -v20
  s_cmp_lg_u64 vcc, 0
  s_cbranch_scc1 L_poll2_retry
  v_exp_f32 v21, v21
  v_exp_f32 v22, v22
  v_cvt_pk_bf16_f32 v16, v128, v129
  v_mul_f32 v9, v21, v128
  v_readlane_b32 s4, v21, 54
  v_fmac_f32 v9, v22, v132
  v_readlane_b32 s6, v22, 54
  v_rcp_f32 v9, v9
  v_cvt_pk_bf16_f32 v17, v130, v131
  v_pk_mul_f32 v[128:129], v[128:129], s[4:5] op_sel_hi:[1,0]
  v_readlane_b32 s8, v9, 54
  v_pk_mul_f32 v[130:131], v[130:131], s[4:5] op_sel_hi:[1,0]
  v_pk_fma_f32 v[128:129], v[132:133], s[6:7], v[128:129] op_sel_hi:[1,0,1]
  v_pk_fma_f32 v[130:131], v[134:135], s[6:7], v[130:131] op_sel_hi:[1,0,1]
  s_mov_b32 exec_hi, 0x0000ffff
  v_pk_mul_f32 v[128:129], v[128:129], s[8:9] op_sel_hi:[1,0]
  v_pk_mul_f32 v[130:131], v[130:131], s[8:9] op_sel_hi:[1,0]
  v_cvt_pk_bf16_f32 v16, v128, v129
  v_cvt_pk_bf16_f32 v17, v130, v131
  s_mov_b32 exec_hi, 0x003fffff
  ds_write_b64 v3, v[16:17] offset:60608
  s_mov_b32 exec_lo, 0
  s_mov_b32 exec_hi, 0x003f0000
  ds_write_b64 v3, v[14:15] offset:60656
L_bar4:
  s_mov_b64 exec, -1
  s_cmp_eq_u32 s15, 6
  s_waitcnt lgkmcnt(0)
  s_cbranch_scc1 L_fin
  s_barrier
  s_mov_b32 exec_lo, 0xf000f
  s_mov_b32 exec_hi, 0xf000f
  ds_read_b128 v[96:99], v6 offset:60608
  ds_read_b128 v[100:103], v6 offset:60672
  ds_read_b128 v[104:107], v6 offset:60736
  ds_read_b128 v[108:111], v6 offset:60800
  ds_read_b128 v[112:115], v6 offset:60864
  ds_read_b128 v[116:119], v6 offset:60928
  ds_read_b128 v[120:123], v6 offset:60992
  ds_read_b128 v[124:127], v6 offset:61056
  s_mov_b64 exec, -1
  s_waitcnt lgkmcnt(7)
  v_mfma_f32_16x16x32_bf16 v[48:51], v[64:67], v[96:99], 0
  s_waitcnt lgkmcnt(6)
  v_mfma_f32_16x16x32_bf16 v[48:51], v[68:71], v[100:103], v[48:51]
  s_waitcnt lgkmcnt(5)
  v_mfma_f32_16x16x32_bf16 v[48:51], v[72:75], v[104:107], v[48:51]
  s_waitcnt lgkmcnt(4)
  v_mfma_f32_16x16x32_bf16 v[48:51], v[76:79], v[108:111], v[48:51]
  s_waitcnt lgkmcnt(3)
  v_mfma_f32_16x16x32_bf16 v[48:51], v[80:83], v[112:115], v[48:51]
  s_waitcnt lgkmcnt(2)
  v_mfma_f32_16x16x32_bf16 v[48:51], v[84:87], v[116:119], v[48:51]
  s_waitcnt lgkmcnt(1)
  v_mfma_f32_16x16x32_bf16 v[48:51], v[88:91], v[120:123], v[48:51]
  s_waitcnt lgkmcnt(0)
  v_mfma_f32_16x16x32_bf16 v[48:51], v[92:95], v[124:127], v[48:51]
  s_mov_b32 exec_lo, 0xf000f
  s_mov_b32 exec_hi, 0xf000f
  s_nop 5
  v_and_or_b32 v48, v48, v18, s56
  v_and_or_b32 v49, v49, v18, s57
  v_and_or_b32 v50, v50, v18, s58
  v_and_or_b32 v51, v51, v18, s59
  buffer_store_dwordx4 v[48:51], v7, s[36:39], s76 offen sc1
  s_cmp_lg_u32 s60, 7
  s_cbranch_scc1 L_fin
  s_mov_b32 exec_lo, 0xffffffff
  s_mov_b32 exec_hi, 0xffffff
  buffer_store_dwordx4 v[60:63], v2, s[36:39], s69 offen sc1
  s_branch L_fin
L_poll2_retry:
  s_add_u32 s69, s69, 1
  s_and_b32 s70, s69, 63
  s_cmp_eq_u32 s70, 63
  s_cselect_b32 s70, s77, s71
  s_add_u32 s0, s0, 1
  s_cmp_lt_u32 s0, 200000
  s_cbranch_scc1 L_poll2
  s_branch L_fin
L_tw4:
  s_setprio 1
  s_cmp_eq_u32 s15, 6
  s_cbranch_scc1 L_cons
  s_cmp_eq_u32 s15, 5
  s_cbranch_scc1 L_tw5
  s_waitcnt vmcnt(0)
  s_cmp_eq_u32 s15, 4
  s_cbranch_scc1 L_bar4
  s_branch L_fin
L_tw5:
  s_mov_b64 exec, -1
  s_cmp_eq_u32 s77, 0
  s_cbranch_scc1 L_finw
  s_waitcnt vmcnt(0)
  s_barrier
  buffer_load_dwordx4 v[204:207], v2, s[36:39], s77 offen offset:0 sc1
  buffer_load_dwordx4 v[208:211], v2, s[36:39], s77 offen offset:1024 sc1
  buffer_load_dwordx4 v[212:215], v2, s[36:39], s77 offen offset:2048 sc1
  buffer_load_dwordx4 v[216:219], v2, s[36:39], s77 offen offset:3072 sc1
  s_sleep 3
L_poll3:
  buffer_load_dwordx4 v[224:227], v2, s[36:39], s77 offen offset:0 sc1
  buffer_load_dwordx4 v[228:231], v2, s[36:39], s77 offen offset:1024 sc1
  buffer_load_dwordx4 v[232:235], v2, s[36:39], s77 offen offset:2048 sc1
  buffer_load_dwordx4 v[236:239], v2, s[36:39], s77 offen offset:3072 sc1
  s_waitcnt vmcnt(7)
  v_xor_b32 v136, s56, v204
  v_xor_b32 v137, s57, v205
  v_xor_b32 v138, s58, v206
  v_xor_b32 v139, s59, v207
  v_or_b32 v14, v136, v137
  v_or3_b32 v14, v14, v138, v139
  s_waitcnt vmcnt(6)
  v_xor_b32 v140, s56, v208
  v_xor_b32 v141, s57, v209
  v_xor_b32 v142, s58, v210
  v_xor_b32 v143, s59, v211
  v_or3_b32 v14, v14, v140, v141
  v_or3_b32 v14, v14, v142, v143
  s_waitcnt vmcnt(5)
  v_xor_b32 v144, s56, v212
  v_xor_b32 v145, s57, v213
  v_xor_b32 v146, s58, v214
  v_xor_b32 v147, s59, v215
  v_or3_b32 v14, v14, v144, v145
  v_or3_b32 v14, v14, v146, v147
  s_waitcnt vmcnt(4)
  v_xor_b32 v148, s56, v216
  v_xor_b32 v149, s57, v217
  v_xor_b32 v150, s58, v218
  v_xor_b32 v151, s59, v219
  v_or3_b32 v14, v14, v148, v149
  v_or3_b32 v14, v14, v150, v151
  v_and_b32 v14, 0xff, v14
  v_cmp_ne_u32 vcc, 0, v14
  s_nop 0
  s_cmp_lg_u64 vcc, 0
  s_cbranch_scc0 L_poll3_ok
  buffer_load_dwordx4 v[204:207], v2, s[36:39], s77 offen offset:0 sc1
  buffer_load_dwordx4 v[208:211], v2, s[36:39], s77 offen offset:1024 sc1
  buffer_load_dwordx4 v[212:215], v2, s[36:39], s77 offen offset:2048 sc1
  buffer_load_dwordx4 v[216:219], v2, s[36:39], s77 offen offset:3072 sc1
  s_waitcnt vmcnt(7)
  v_xor_b32 v136, s56, v224
  v_xor_b32 v137, s57, v225
  v_xor_b32 v138, s58, v226
  v_xor_b32 v139, s59, v227
  v_or_b32 v14, v136, v137
  v_or3_b32 v14, v14, v138, v139
  s_waitcnt vmcnt(6)
  v_xor_b32 v140, s56, v228
  v_xor_b32 v141, s57, v229
  v_xor_b32 v142, s58, v230
  v_xor_b32 v143, s59, v231
  v_or3_b32 v14, v14, v140, v141
  v_or3_b32 v14, v14, v142, v143
  s_waitcnt vmcnt(5)
  v_xor_b32 v144, s56, v232
  v_xor_b32 v145, s57, v233
  v_xor_b32 v146, s58, v234
  v_xor_b32 v147, s59, v235
  v_or3_b32 v14, v14, v144, v145
  v_or3_b32 v14, v14, v146, v147
  s_waitcnt vmcnt(4)
  v_xor_b32 v148, s56, v236
  v_xor_b32 v149, s57, v237
  v_xor_b32 v150, s58, v238
  v_xor_b32 v151, s59, v239
  v_or3_b32 v14, v14, v148, v149
  v_or3_b32 v14, v14, v150, v151
  v_and_b32 v14, 0xff, v14
  v_cmp_ne_u32 vcc, 0, v14
  s_nop 0
  s_cmp_lg_u64 vcc, 0
  s_cbranch_scc1 L_poll3_retry
L_poll3_ok:
  v_pk_add_f32 v[136:137], v[136:137], v[140:141]
  v_pk_add_f32 v[144:145], v[144:145], v[148:149]
  v_pk_add_f32 v[138:139], v[138:139], v[142:143]
  v_pk_add_f32 v[146:147], v[146:147], v[150:151]
  v_pk_add_f32 v[136:137], v[136:137], v[144:145]
  v_pk_add_f32 v[138:139], v[138:139], v[146:147]
  s_nop 1
  v_permlane32_swap_b32 v136, v138
  v_permlane32_swap_b32 v137, v139
  v_pk_add_f32 v[140:141], v[136:137], v[138:139]
  v_pk_add_f32 v[142:143], v[136:137], v[138:139]
  s_nop 1
  v_permlane16_swap_b32 v140, v142
  v_permlane16_swap_b32 v141, v143
  v_pk_add_f32 v[140:141], v[140:141], v[142:143]
  s_nop 1
  v_add_f32_dpp v140, v140, v140 row_ror:8 row_mask:0xf bank_mask:0xf
  v_add_f32_dpp v141, v141, v141 row_ror:8 row_mask:0xf bank_mask:0xf
  s_mov_b32 exec_lo, 0xff
  s_mov_b32 exec_hi, 0xff
  v_pk_add_f32 v[140:141], v[140:141], v[60:61]
  v_cvt_pk_bf16_f32 v8, v140, v141
  buffer_store_dword v8, v3, s[52:55], s78 offen sc1
  s_branch L_fin
L_finw:
  s_waitcnt vmcnt(0)
L_fin:
L_end:
  s_endpgm
L_poll3_retry:
  s_add_u32 s0, s0, 1
  s_cmp_lt_u32 s0, 200000
  s_cbranch_scc1 L_poll3
  s_branch L_fin
L_rank2:
  v_lshrrev_b32 v10, 3, v0
  v_lshlrev_b32 v10, 4, v10
  v_xor_b32 v10, s2, v10
  v_and_b32 v10, 0xf8, v10
  v_and_b32 v15, 7, v0
  v_or_b32 v10, v10, v15
  v_lshlrev_b32 v15, 7, v10
  v_mov_b32 v60, s56
  v_mov_b32 v61, s57
  v_mov_b32 v62, s58
  v_mov_b32 v63, s59
  s_lshl_b32 s70, s2, 7
  s_add_u32 s70, s70, 1572864
  s_mov_b32 s69, 1572864
  s_mov_b32 exec_lo, 0xff
  s_mov_b32 exec_hi, 0x0
  buffer_load_dwordx4 v[64:67], v15, s[36:39], s69 offen sc1
  s_mov_b64 exec, 0xff
  buffer_store_dwordx4 v[60:63], v2, s[36:39], s70 offen sc1
  s_mov_b32 exec_lo, 0xff
  s_mov_b32 exec_hi, 0x0
  s_waitcnt vmcnt(1)
  v_xor_b32 v64, s56, v64
  v_xor_b32 v65, s57, v65
  v_xor_b32 v66, s58, v66
  v_xor_b32 v67, s59, v67
  v_or3_b32 v10, v64, v65, v66
  v_or_b32 v10, v10, v67
  v_cmp_eq_u32 s[4:5], 0, v10
  s_nop 0
  s_bcnt1_i32_b64 s69, s[4:5]
  s_cmp_ge_u32 s69, 2
  s_cselect_b32 s70, 1, 2
  s_cmp_ge_u32 s69, 5
  s_cselect_b32 s69, 3, s70
  v_mov_b32 v10, s69
  ds_write_b32 v5, v10 offset:428
  s_cmp_lg_u32 s69, 2
  s_cbranch_scc1 L_rp_end
  s_mov_b32 s47, 0
  s_mov_b32 s45, 1572864
L_rp:
  s_sleep 4
  buffer_load_dwordx4 v[64:67], v15, s[36:39], s45 offen sc1
  s_add_u32 s47, s47, 1
  s_waitcnt vmcnt(0)
  v_xor_b32 v64, s56, v64
  v_xor_b32 v65, s57, v65
  v_xor_b32 v66, s58, v66
  v_xor_b32 v67, s59, v67
  v_or3_b32 v10, v64, v65, v66
  v_or_b32 v10, v10, v67
  v_cmp_eq_u32 s[4:5], 0, v10
  s_nop 0
  s_bcnt1_i32_b64 s69, s[4:5]
  s_cmp_ge_u32 s47, 4
  s_cselect_b32 s69, 64, s69
  s_cmp_lt_u32 s69, 5
  s_cbranch_scc1 L_rp
  v_mov_b32 v10, 1
  ds_write_b32 v5, v10 offset:428
L_rp_end:
  s_mov_b64 exec, -1
  s_branch L_nogate3
L_red0:
  s_mov_b32 s77, 0
  s_lshl3_add_u32 s69, s63, s61
  s_cmp_ge_u32 s69, 10
  s_cbranch_scc1 L_red0_done
  s_and_b32 s70, s69, 1
  s_mul_i32 s78, s70, 2560
  s_lshr_b32 s70, s69, 1
  s_lshl_b32 s70, s70, 5
  s_add_u32 s78, s78, s70
  s_mul_i32 s70, s64, 160
  s_add_u32 s78, s78, s70
  v_bfe_u32 v3, v0, 2, 1
  v_mul_u32_u24 v3, 1280, v3
  v_and_b32 v10, 3, v0
  v_lshl_add_u32 v3, v10, 3, v3
  s_lshl_b32 s69, s69, 12
  s_add_u32 s77, s69, s79
  s_setprio 3
  v_lshrrev_b32 v10, 5, v0
  v_lshl_add_u32 v3, v10, 2, v3
  s_mov_b32 exec_lo, 0xff
  s_mov_b32 exec_hi, 0xff
  buffer_load_dword v10, v3, s[48:51], s78 offen
  s_waitcnt vmcnt(0)
  buffer_store_dword v10, v3, s[52:55], s78 offen sc1
  v_lshlrev_b32 v60, 16, v10
  v_and_b32 v61, s68, v10
  s_mov_b64 exec, -1
  buffer_load_dwordx4 v[224:227], v2, s[36:39], s77 offen offset:0 sc1
  buffer_load_dwordx4 v[228:231], v2, s[36:39], s77 offen offset:1024 sc1
  buffer_load_dwordx4 v[232:235], v2, s[36:39], s77 offen offset:2048 sc1
  buffer_load_dwordx4 v[236:239], v2, s[36:39], s77 offen offset:3072 sc1
  s_branch L_red0_done
L_gather:
  s_lshl1_add_u32 s69, s63, s67
  s_mul_i32 s69, s69, 96
  s_mul_i32 s70, s63, 768
  v_lshlrev_b32 v3, 4, v0
  v_add_u32 v4, s70, v3
  s_add_u32 s70, s69, 2304
  s_add_u32 s69, s69, 2976
  s_mov_b32 exec_lo, 0
  s_mov_b32 exec_hi, 0x003f0000
  v_add_u32 v4, s70, v3
  s_mov_b32 exec_hi, 0x0fc00000
  v_add_u32 v4, s69, v3
  s_andn2_b32 s69, s65, 3
  s_add_u32 s69, s69, s66
  s_mul_i32 s69, s69, 23040
  s_add_u32 s70, s69, 4608
  s_add_u32 s71, s69, 9216
  s_add_u32 s76, s69, 13824
  s_add_u32 s77, s69, 18432
  s_mov_b32 exec_lo, -1
  s_mov_b32 exec_hi, 0x0fffffff
L_poll1:
  buffer_load_dwordx4 v[8:11], v4, s[36:39], s69 offen sc1 nt
  buffer_load_dwordx4 v[12:15], v4, s[36:39], s70 offen sc1 nt
  buffer_load_dwordx4 v[16:19], v4, s[36:39], s71 offen sc1 nt
  buffer_load_dwordx4 v[20:23], v4, s[36:39], s76 offen sc1 nt
  buffer_load_dwordx4 v[24:27], v4, s[36:39], s77 offen sc1 nt
  s_waitcnt vmcnt(0)
  v_xor_b32 v8, s56, v8
  v_xor_b32 v9, s57, v9
  v_xor_b32 v10, s58, v10
  v_xor_b32 v11, s59, v11
  v_xor_b32 v12, s56, v12
  v_xor_b32 v13, s57, v13
  v_xor_b32 v14, s58, v14
  v_xor_b32 v15, s59, v15
  v_xor_b32 v16, s56, v16
  v_xor_b32 v17, s57, v17
  v_xor_b32 v18, s58, v18
  v_xor_b32 v19, s59, v19
  v_xor_b32 v20, s56, v20
  v_xor_b32 v21, s57, v21
  v_xor_b32 v22, s58, v22
  v_xor_b32 v23, s59, v23
  v_xor_b32 v24, s56, v24
  v_xor_b32 v25, s57, v25
  v_xor_b32 v26, s58, v26
  v_xor_b32 v27, s59, v27
  v_or_b32 v2, v8, v9
  v_or3_b32 v2, v2, v10, v11
  v_or3_b32 v2, v2, v12, v13
  v_or3_b32 v2, v2, v14, v15
  v_or3_b32 v2, v2, v16, v17
  v_or3_b32 v2, v2, v18, v19
  v_or3_b32 v2, v2, v20, v21
  v_or3_b32 v2, v2, v22, v23
  v_or3_b32 v2, v2, v24, v25
  v_or3_b32 v2, v2, v26, v27
  v_and_b32 v2, 0xff, v2
  v_cmp_ne_u32 vcc, 0, v2
  s_nop 0
  s_cmp_eq_u64 vcc, 0
  s_cbranch_scc1 L_poll1_ok
  s_sleep 8
  s_add_u32 s0, s0, 1
  s_cmp_lt_u32 s0, 200000
  s_cbranch_scc1 L_poll1
  s_branch L_fin
L_poll1_ok:
  s_mov_b64 exec, -1
  v_lshlrev_b32 v2, 3, v0
  v_pk_add_f32 v[8:9], v[8:9], v[12:13]
  v_pk_add_f32 v[10:11], v[10:11], v[14:15]
  v_pk_add_f32 v[8:9], v[8:9], v[16:17]
  v_pk_add_f32 v[10:11], v[10:11], v[18:19]
  v_pk_add_f32 v[8:9], v[8:9], v[20:21]
  v_pk_add_f32 v[10:11], v[10:11], v[22:23]
  v_pk_add_f32 v[8:9], v[8:9], v[24:25]
  v_pk_add_f32 v[10:11], v[10:11], v[26:27]
  v_cvt_pk_bf16_f32 v60, v8, v9
  v_cvt_pk_bf16_f32 v61, v10, v11
  v_mov_b32 v3, 0
  v_mov_b32 v4, 1
  s_mov_b32 exec_lo, 0xffffffff
  s_mov_b32 exec_hi, 0xffff
  ds_write_b64 v2, v[60:61] offset:0
  s_mov_b64 exec, 1
  ds_write_b32 v3, v4 offset:416
  s_mov_b64 exec, -1
  v_lshlrev_b32 v40, 16, v60
  v_and_b32 v41, s68, v60
  v_lshlrev_b32 v42, 16, v61
  v_and_b32 v43, s68, v61
  v_mul_f32 v48, 0xbfb8aa3b, v40
  v_mul_f32 v49, 0xbfb8aa3b, v41
  v_mul_f32 v50, 0xbfb8aa3b, v42
  v_mul_f32 v51, 0xbfb8aa3b, v43
  v_mov_b32_dpp v44, v40 row_shl:6 row_mask:0xf bank_mask:0xf
  v_mov_b32_dpp v45, v41 row_shl:6 row_mask:0xf bank_mask:0xf
  v_mov_b32_dpp v46, v42 row_shl:6 row_mask:0xf bank_mask:0xf
  v_mov_b32_dpp v47, v43 row_shl:6 row_mask:0xf bank_mask:0xf
  v_exp_f32 v48, v48
  v_exp_f32 v49, v49
  v_exp_f32 v50, v50
  v_exp_f32 v51, v51
  v_add_f32 v48, 1.0, v48
  v_add_f32 v49, 1.0, v49
  v_add_f32 v50, 1.0, v50
  v_add_f32 v51, 1.0, v51
  v_rcp_f32 v48, v48
  v_rcp_f32 v49, v49
  v_rcp_f32 v50, v50
  v_rcp_f32 v51, v51
  v_mul_f32 v48, v48, v40
  v_mul_f32 v49, v49, v41
  v_mul_f32 v50, v50, v42
  v_mul_f32 v51, v51, v43
  v_cvt_pk_bf16_f32 v40, v48, v49
  v_cvt_pk_bf16_f32 v41, v50, v51
  v_lshlrev_b32 v48, 16, v40
  v_and_b32 v49, s68, v40
  v_lshlrev_b32 v50, 16, v41
  v_and_b32 v51, s68, v41
  v_mul_f32 v48, v48, v44
  v_mul_f32 v49, v49, v45
  v_mul_f32 v50, v50, v46
  v_mul_f32 v51, v51, v47
  v_cvt_pk_bf16_f32 v40, v48, v49
  v_cvt_pk_bf16_f32 v41, v50, v51
  v_lshlrev_b32 v60, 16, v40
  v_and_b32 v61, s68, v40
  v_lshlrev_b32 v62, 16, v41
  v_and_b32 v63, s68, v41
  s_branch L_waitq
.section .rodata,"a"
.p2align 6
.amdhsa_kernel parallel_sum__sliding_block_cached__glu_gated_swiglu__decode_kernel
  .amdhsa_next_free_vgpr 256
  .amdhsa_next_free_sgpr 102
  .amdhsa_accum_offset 256
  .amdhsa_group_segment_fixed_size 0
  .amdhsa_kernarg_size 96
  .amdhsa_user_sgpr_count 2
  .amdhsa_user_sgpr_kernarg_segment_ptr 1
  .amdhsa_system_sgpr_workgroup_id_x 1
  .amdhsa_float_denorm_mode_32 3
.end_amdhsa_kernel
```
